```python
import torch

def _softmax(x, axis=-1):
    return torch.softmax(x, dim=axis)
def _gelu(x):
    return torch.nn.functional.gelu(x, approximate="tanh")
def _silu(x):
    return torch.nn.functional.silu(x)
def _sigmoid(x):
    return torch.sigmoid(x)
def _layernorm(x, axis=-1, eps=1e-5):
    m = x.mean(dim=axis, keepdim=True)
    v = x.var(dim=axis, keepdim=True, unbiased=False)
    return (x - m) / torch.sqrt(v + eps)
def _scatter_add(tgt, idx, src, axis=0):
    return tgt.clone().index_add_(axis, idx, src)
def _segment_sum(src, seg, n):
    out = torch.zeros((n,) + src.shape[1:], dtype=src.dtype)
    return out.index_add_(0, seg, src)
def _pad(x, pw):
    flat = tuple(v for pair in reversed(pw) for v in pair)
    return torch.nn.functional.pad(x, flat)

kernel_name = 'recurrent_scan__sliding_local_dilated__dense_activation_relu__prompt'

def setup_inputs():

    _w = (lambda a: (lambda t: t.to(torch.bfloat16) if t.is_floating_point() else t)(torch.as_tensor(a)))
    def _A_setup():
        B, S, D = 1, 2048, 448
        return {
            "x": _w((lambda *s: torch.randn(*s, dtype=torch.bfloat16) * 0.05)(B, S, D)),
            "wqkv": _w((lambda *s: torch.randn(*s, dtype=torch.bfloat16) * 0.05)(D, 3 * D)),
            "wo": _w((lambda *s: torch.randn(*s, dtype=torch.bfloat16) * 0.05)(D, D)),
        }
    _A_in = _A_setup()

    def _B_setup():
        B, S, D, Dff = 1, 2048, 448, 1792
        return {
            "x": _w((lambda *s: torch.randn(*s, dtype=torch.bfloat16) * 0.05)(B, S, D)),
            "w1": _w((lambda *s: torch.randn(*s, dtype=torch.bfloat16) * 0.05)(D, Dff)),
            "w2": _w((lambda *s: torch.randn(*s, dtype=torch.bfloat16) * 0.05)(Dff, D)),
        }
    _B_in = _B_setup()

    return {
        "A_x": _A_in["x"],
        "A_wqkv": _A_in["wqkv"],
        "A_wo": _A_in["wo"],
        "B_x": _B_in["x"],
        "B_w1": _B_in["w1"],
        "B_w2": _B_in["w2"],
    }

def reference(A_x, A_wqkv, A_wo, B_x, B_w1, B_w2):
    def _A_ref(x, wqkv, wo):
        B, S, D = x.shape
        H = 16; Dh = D // H
        W, dil = 8, 2
        qkv = (lambda x, *d: x.permute(*d))((x @ wqkv).reshape(B, S, 3, H, Dh), 2, 0, 3, 1, 4)
        q, k, v = qkv[0], qkv[1], qkv[2]
        scale = Dh ** -0.5
        pos = torch.arange(S)
        off = torch.arange(W) * dil
        idx = pos[:, None] - off[None, :]
        mask = idx >= 0
        idx_c = torch.where(mask, idx, 0).reshape(-1)
        kg = k[:, :, idx_c, :].reshape(B, H, S, W, Dh)
        vg = v[:, :, idx_c, :].reshape(B, H, S, W, Dh)
        logits = torch.einsum("bhsd,bhswd->bhsw", q, kg) * scale
        logits = torch.where(mask[None, None, :, :], logits, -1e9)
        attn = _softmax(logits, axis=-1)
        o = torch.einsum("bhsw,bhswd->bhsd", attn, vg)
        return (lambda x, *d: x.permute(*d))(o, 0, 2, 1, 3).reshape(B, S, D) @ wo

    def _B_ref(x, w1, w2):
        h = torch.einsum("bsd,df->bsf", x, w1)
        zero = torch.zeros_like(h)
        h = torch.maximum(h, zero)
        return torch.einsum("bsf,fd->bsd", h, w2)

    x = A_x
    xn = _layernorm(x, axis=-1)
    s = _A_ref(xn, A_wqkv, A_wo)
    g = _silu(_B_ref(xn, B_w1, B_w2))
    return x + s * g
```

```asm
; @launch grid=(256,1,1) block=(256,1,1) lds=163840
.amdgcn_target "amdgcn-amd-amdhsa--gfx950"
.text
.globl recurrent_scan__sliding_local_dilated__dense_activation_relu__prompt_kernel
.p2align 8
.type recurrent_scan__sliding_local_dilated__dense_activation_relu__prompt_kernel,@function
recurrent_scan__sliding_local_dilated__dense_activation_relu__prompt_kernel:
s_cmp_ge_u32 s2, 256
s_cbranch_scc1 K_END
s_load_dwordx16 s[4:19], s[0:1], 0
s_load_dwordx2 s[20:21], s[0:1], 64
s_getpc_b64 s[22:23]
s_lshr_b32 s63, s2, 3
s_lshl_b32 s63, s63, 11
v_lshl_add_u32 v1, v0, 3, s63
global_load_dword v2, v1, s[22:23]
v_lshrrev_b32 v1, 6, v0
v_and_b32 v0, 63, v0
v_readfirstlane_b32 s3, v1
s_bfe_u32 s60, s2, 0x10002
s_bfe_u32 s61, s2, 0x30003
s_and_b32 s63, s2, 3
s_lshl_b32 s63, s63, 1
s_bfe_u32 s64, s2, 0x10006
s_add_u32 s62, s63, s64
s_lshr_b32 s63, s2, 7
s_mul_i32 s63, s63, 0
s_add_u32 s63, s63, s61
s_mul_i32 s64, s62, 1
s_add_u32 s63, s63, s64
s_mul_i32 s64, s63, 37
s_lshr_b32 s64, s64, 8
s_mul_i32 s64, s64, 7
s_sub_u32 s63, s63, s64
s_lshl_b32 s66, s63, 7
s_mul_i32 s65, s60, 896
s_lshl_b32 s63, s61, 7
s_lshl_b32 s64, s3, 5
s_add_u32 s63, s63, s64
v_lshrrev_b32 v7, 3, v0
v_add_u32 v3, s63, v7
v_mul_u32_u24 v3, 1792, v3
v_lshrrev_b32 v4, 4, v0
v_and_b32 v8, 7, v0
v_xor_b32 v5, v4, v8
v_lshl_add_u32 v33, v5, 4, v3
v_xor_b32 v6, 64, v33
v_add_u32 v34, 13312, v6
v_add_u32 v35, 26624, v33
v_add_u32 v36, 39936, v6
s_and_b32 s72, s3, 1
s_lshr_b32 s73, s3, 1
s_lshl_b32 s70, s72, 2
s_lshl_b32 s69, s3, 12
s_cmp_lt_u32 s2, 128
s_cbranch_scc1 H_FFN
s_mul_i32 s64, s3, 57344
s_add_u32 s64, s64, 14336
s_cmp_eq_u32 s61, 0
s_cselect_b32 s64, 0x80000000, s64
v_subrev_u32 v37, s64, v6
s_lshl_b32 s64, s3, 4
s_mov_b64 s[54:55], 0xffff
s_lshl_b64 s[54:55], s[54:55], s64
v_and_b32 v3, 2, v7
v_add_u32 v3, s70, v3
v_sub_u32 v3, v8, v3
v_and_b32 v3, 7, v3
v_cmp_ne_u32 s[52:53], 7, v3
v_mov_b32 v5, 0x80000000
s_mul_i32 s63, s62, 112
s_mul_i32 s64, s3, 21504
s_add_u32 s63, s63, s64
v_mul_u32_u24 v4, 2688, v7
v_lshl_add_u32 v4, v3, 4, v4
v_add_u32 v4, s63, v4
v_cndmask_b32 v40, v5, v4, s[52:53]
v_add_u32 v39, 128, v40
v_add_u32 v38, 256, v40
s_mul_i32 s67, s66, 1344
s_mul_i32 s68, s3, 3072
s_waitcnt lgkmcnt(0)
s_add_u32 s24, s4, s65
s_addc_u32 s25, s5, 0
s_sub_u32 s26, 1835008, s65
s_mov_b32 s27, 0x20000
s_sub_u32 s28, s6, 256
s_subb_u32 s29, s7, 0
s_mov_b32 s30, 1204480
s_mov_b32 s31, 0x20000
s_add_u32 m0, s69, 2048
s_nop 0
buffer_load_dwordx4 v33, s[24:27], s66 offen offset:0 lds
buffer_load_dwordx4 v34, s[24:27], s66 offen offset:1024 lds
buffer_load_dwordx4 v35, s[24:27], s66 offen offset:2048 lds
buffer_load_dwordx4 v36, s[24:27], s66 offen offset:3072 lds
s_mov_b32 m0, 1024
s_mov_b64 exec, s[54:55]
buffer_load_dwordx4 v37, s[24:27], s66 offen lds
s_mov_b64 exec, -1
s_add_u32 m0, s68, 55296
s_nop 0
buffer_load_dwordx4 v38, s[28:31], s67 offen offset:0 lds
s_mov_b64 exec, s[52:53]
buffer_load_dwordx4 v39, s[28:31], s67 offen offset:1024 lds
s_mov_b64 exec, -1
buffer_load_dwordx4 v40, s[28:31], s67 offen offset:2048 lds
v_add_u32 v41, 86016, v38
v_add_u32 v42, 86016, v39
v_add_u32 v43, 86016, v40
s_branch R_QKV
H_FFN:
s_mul_i32 s63, s62, 448
s_and_b32 s63, s63, 0xffffff80
s_mul_i32 s64, s3, 28672
s_add_u32 s63, s63, s64
v_lshrrev_b32 v3, 5, v0
v_bfe_u32 v4, v0, 1, 4
v_xor_b32 v4, v3, v4
v_xor_b32 v4, s70, v4
v_mul_u32_u24 v3, 3584, v3
v_lshl_add_u32 v3, v4, 5, v3
v_and_b32 v4, 1, v0
v_lshl_add_u32 v3, v4, 4, v3
v_add_u32 v37, s63, v3
v_xor_b32 v6, 64, v37
v_add_u32 v38, 6144, v6
v_add_u32 v39, 12288, v37
v_add_u32 v40, 18432, v6
s_mul_i32 s67, s66, 1792
s_memrealtime s[56:57]
s_or_b32 s63, s2, s3
s_cmp_eq_u32 s63, 0
s_cselect_b32 s46, 256, 0
s_mov_b32 s47, 0x20000
v_mov_b32 v3, 0
s_waitcnt lgkmcnt(0)
s_add_u32 s24, s4, s65
s_addc_u32 s25, s5, 0
s_sub_u32 s26, 1835008, s65
s_mov_b32 s27, 0x20000
s_or_b32 s63, s56, 1
v_mov_b32 v4, s63
s_mov_b32 s44, s18
s_mov_b32 s45, s19
buffer_store_dword v4, v3, s[44:47], 0 offen sc1
s_mov_b32 s28, s12
s_mov_b32 s29, s13
s_mov_b32 s30, 1605632
s_mov_b32 s31, 0x20000
s_add_u32 m0, s69, 65536
s_nop 0
buffer_load_dwordx4 v33, s[24:27], s66 offen offset:0 lds
buffer_load_dwordx4 v34, s[24:27], s66 offen offset:1024 lds
buffer_load_dwordx4 v35, s[24:27], s66 offen offset:2048 lds
buffer_load_dwordx4 v36, s[24:27], s66 offen offset:3072 lds
s_add_u32 m0, s69, 0
s_nop 0
buffer_load_dwordx4 v37, s[28:31], s67 offen offset:0 lds
buffer_load_dwordx4 v38, s[28:31], s67 offen offset:1024 lds
buffer_load_dwordx4 v39, s[28:31], s67 offen offset:2048 lds
buffer_load_dwordx4 v40, s[28:31], s67 offen offset:3072 lds
v_add_u32 v41, 114688, v37
v_add_u32 v42, 114688, v38
v_add_u32 v43, 114688, v39
v_add_u32 v44, 114688, v40
s_branch R_FFN
.p2align 12
R_FFN:
s_mov_b32 s32, s20
s_mov_b32 s33, s21
s_mov_b32 s34, 13205504
s_mov_b32 s35, 0x20000
v_and_b32 v204, 15, v0
v_lshrrev_b32 v205, 4, v0
s_lshl_b32 s63, s73, 13
s_lshl_b32 s64, s72, 12
s_add_u32 s63, s63, s64
s_add_u32 s63, s63, 65536
v_lshrrev_b32 v3, 1, v204
v_xor_b32 v3, v205, v3
v_lshlrev_b32 v3, 4, v3
v_lshl_add_u32 v3, v204, 7, v3
v_add_u32 v45, s63, v3
v_xor_b32 v46, 64, v45
v_xor_b32 v47, 4096, v45
v_xor_b32 v48, 4096, v46
v_bfe_u32 v3, v0, 2, 2
v_lshl_add_u32 v4, v205, 3, v3
v_lshlrev_b32 v4, 9, v4
v_and_b32 v5, 3, v0
v_lshl_add_u32 v4, v5, 3, v4
v_bfe_u32 v3, v0, 2, 3
s_lshl_b32 s70, s73, 2
s_mul_i32 s71, s73, -3
s_and_b32 s63, s62, 1
s_lshl_b32 s63, s63, 1
s_mul_i32 s64, s72, 7
s_add_u32 s63, s63, s64
s_add_u32 s64, s63, s71
s_add_u32 s63, s63, s70
s_add_u32 s65, s63, 0
v_xor_b32 v5, s65, v3
v_lshl_add_u32 v49, v5, 5, v4
s_add_u32 s65, s63, 1
v_xor_b32 v5, s65, v3
v_lshl_add_u32 v50, v5, 5, v4
s_add_u32 s65, s63, 2
v_xor_b32 v5, s65, v3
v_lshl_add_u32 v51, v5, 5, v4
s_add_u32 s65, s64, 3
v_xor_b32 v5, s65, v3
v_lshl_add_u32 v52, v5, 5, v4
s_add_u32 s65, s64, 4
v_xor_b32 v5, s65, v3
v_lshl_add_u32 v53, v5, 5, v4
s_add_u32 s65, s64, 5
v_xor_b32 v5, s65, v3
v_lshl_add_u32 v54, v5, 5, v4
s_add_u32 s65, s64, 6
v_xor_b32 v5, s65, v3
v_lshl_add_u32 v55, v5, 5, v4
v_mov_b32 v3, 0x3f803f80
v_accvgpr_write_b32 a0, v3
v_accvgpr_write_b32 a1, v3
v_accvgpr_write_b32 a2, v3
v_accvgpr_write_b32 a3, v3
s_lshl_b32 s63, s73, 8
s_lshl_b32 s64, s72, 7
s_add_u32 s63, s63, s64
s_add_u32 s63, s63, 131072
v_lshlrev_b32 v206, 2, v204
v_add_u32 v206, s63, v206
v_xor_b32 v207, 128, v206
s_lshl_b32 s63, s72, 3
s_add_u32 s64, s63, s71
s_add_u32 s63, s63, s70
s_lshl_b32 s63, s63, 6
s_add_u32 s64, s64, 4
s_lshl_b32 s64, s64, 6
v_lshlrev_b32 v208, 4, v205
v_add_u32 v208, 131072, v208
v_add_u32 v209, s64, v208
v_add_u32 v208, s63, v208
s_lshl_b32 s63, s72, 10
v_lshlrev_b32 v210, 4, v0
v_add_u32 v210, s63, v210
v_xor_b32 v211, 1024, v210
s_lshl_b32 s63, s60, 3
s_add_u32 s63, s63, s61
s_lshl_b32 s63, s63, 1
s_add_u32 s63, s63, s73
s_mul_i32 s63, s63, 144
s_mul_i32 s64, s62, 14
s_add_u32 s63, s63, s64
s_mul_i32 s64, s72, 7
s_add_u32 s63, s63, s64
s_add_u32 s63, s63, 32
s_add_u32 s70, s70, s63
s_add_u32 s71, s71, s63
s_lshl_b32 s70, s70, 11
s_lshl_b32 s71, s71, 11
v_and_b32 v3, 1, v0
v_cmp_ne_u32 s[56:57], 0, v3
v_and_b32 v3, 2, v0
v_cmp_ne_u32 s[58:59], 0, v3
v_and_b32 v3, 4, v0
v_cmp_ne_u32 s[52:53], 0, v3
v_and_b32 v3, 8, v0
v_cmp_ne_u32 s[54:55], 0, v3
s_lshl_b32 s65, s60, 3
s_add_u32 s63, s65, s62
s_lshl_b32 s63, s63, 14
s_add_u32 s63, s63, 9535488
s_lshl_b32 s64, s3, 12
s_add_u32 s64, s64, s63
v_lshl_add_u32 v214, v0, 4, s64
s_lshl_b32 s64, s72, 1
s_add_u32 s64, s64, s73
s_lshl_b32 s64, s64, 3
s_add_u32 s64, s64, s61
s_lshl_b32 s64, s64, 9
s_add_u32 s63, s63, s64
v_bfe_u32 v3, v0, 2, 2
v_lshlrev_b32 v3, 4, v3
v_lshl_add_u32 v3, v205, 2, v3
v_and_b32 v4, 3, v0
v_add_u32 v3, v3, v4
v_lshl_add_u32 v212, v3, 3, s63
s_add_u32 s63, s65, s61
s_lshl_b32 s63, s63, 2
s_add_u32 s63, s63, s3
s_lshl_b32 s63, s63, 12
s_add_u32 s63, s63, 9797632
v_lshl_add_u32 v3, v204, 4, s63
v_cmp_lt_u32 vcc, 31, v0
s_nop 1
v_cndmask_b32 v214, v214, v3, vcc
s_lshl_b32 s64, s62, 9
s_add_u32 s63, s63, s64
v_lshl_add_u32 v213, v0, 3, s63
v_mov_b32 v4, 0x80000000
v_cndmask_b32 v213, v213, v4, vcc
v_lshl_add_u32 v217, v204, 4, s63
v_lshrrev_b32 v5, 2, v204
v_cmp_eq_u32 s[22:23], v5, v205
s_nop 1
v_cndmask_b32 v217, v4, v217, s[22:23]
v_mov_b32 v215, 1.0
v_mov_b32 v4, 0xbb124925
v_cndmask_b32 v215, v215, v4, vcc
s_lshl_b32 s63, s3, 8
s_add_u32 s63, s63, 132096
v_lshl_add_u32 v216, v0, 3, s63
s_lshl_b32 s63, s3, 7
s_add_u32 s63, s63, 131072
v_lshl_add_u32 v3, v204, 3, s63
v_cndmask_b32 v216, v216, v3, vcc
s_bfe_u32 s63, s2, 0x20001
s_lshl_b32 s63, s63, 2
s_bfe_u32 s82, s2, 0x20003
s_add_u32 s63, s63, s82
s_lshl_b32 s63, s63, 1
s_and_b32 s65, s2, 1
s_add_u32 s74, s63, s65
s_lshr_b32 s75, s2, 5
s_lshl_b32 s63, s75, 2
s_lshr_b32 s63, 808464432, s63
s_and_b32 s63, s63, 15
s_lshl_b32 s64, s82, 1
s_add_u32 s63, s63, s64
s_sub_u32 s64, s63, 7
s_cmp_ge_u32 s63, 7
s_cselect_b32 s83, s64, s63
s_lshl_b32 s65, s65, 2
s_add_u32 s65, s65, s3
s_mul_i32 s78, s65, 200704
s_add_u32 s79, s78, 200704
s_mul_i32 s64, s83, 28672
s_add_u32 s76, s78, s64
s_mul_i32 s80, s3, 100352
s_add_u32 s81, s80, 100352
s_mul_i32 s64, s82, 25088
s_add_u32 s77, s80, s64
s_xor_b32 s63, s74, 1
s_mul_i32 s63, s63, 144
s_add_u32 s63, s63, 32
s_lshl_b32 s63, s63, 1
s_add_u32 s63, s63, s72
s_lshl_b32 s63, s63, 10
v_lshl_add_u32 v3, v0, 4, s63
s_mul_i32 s64, s65, 28672
v_add_u32 v10, s64, v3
s_xor_b32 s64, s65, 1
s_mul_i32 s64, s64, 28672
v_add_u32 v11, s64, v3
v_lshrrev_b32 v3, 3, v0
v_mul_u32_u24 v3, 896, v3
v_bfe_u32 v4, v0, 4, 1
v_lshlrev_b32 v4, 2, v4
v_and_b32 v5, 7, v0
v_xor_b32 v4, v4, v5
s_lshl_b32 s64, s75, 7
v_lshl_add_u32 v3, v4, 4, v3
v_add_u32 v12, s64, v3
v_add_u32 v13, 6144, v12
s_lshl_b32 s85, s3, 11
s_cmp_lt_u32 s2, 224
s_cselect_b32 s63, 1605632, 0
s_cselect_b32 s64, 401408, 0
s_mov_b32 s36, s14
s_mov_b32 s37, s15
s_mov_b32 s38, s63
s_mov_b32 s39, 0x20000
s_mov_b32 s40, s8
s_mov_b32 s41, s9
s_mov_b32 s42, s64
s_mov_b32 s43, 0x20000
s_lshl_b32 s64, s73, 6
v_bfe_u32 v3, v0, 2, 2
v_lshrrev_b32 v4, 5, v0
v_lshl_add_u32 v3, v4, 3, v3
v_lshlrev_b32 v3, 7, v3
v_bfe_u32 v4, v0, 3, 1
v_lshl_add_u32 v3, v4, 6, v3
v_bfe_u32 v4, v0, 4, 1
v_lshl_add_u32 v3, v4, 5, v3
v_and_b32 v4, 3, v0
v_lshl_add_u32 v3, v4, 3, v3
v_xor_b32 v3, s64, v3
v_add_u32 v14, s85, v3
v_xor_b32 v15, 64, v14
v_add_u32 v16, 65536, v14
v_add_u32 v17, 65536, v15
v_add_u32 v18, 131072, v14
v_add_u32 v19, 131072, v15
v_xor_b32 v20, 2048, v14
v_xor_b32 v21, 2048, v15
v_xor_b32 v22, 2048, v16
v_xor_b32 v23, 2048, v17
v_xor_b32 v24, 2048, v18
v_xor_b32 v25, 2048, v19
s_and_b32 s63, s74, 15
s_mul_i32 s63, s63, 114688
s_lshr_b32 s64, s74, 4
s_mul_i32 s64, s64, 896
s_add_u32 s63, s63, s64
s_lshl_b32 s64, s75, 7
s_add_u32 s84, s63, s64
s_mul_i32 s63, s3, 28672
s_add_u32 s63, s63, s84
v_lshrrev_b32 v3, 3, v0
v_and_b32 v4, 7, v0
v_xor_b32 v4, v3, v4
v_mul_u32_u24 v3, 1792, v3
v_lshl_add_u32 v3, v4, 4, v3
v_add_u32 v26, s63, v3
s_lshr_b32 s63, s74, 4
s_lshl_b32 s63, s63, 2
s_bfe_u32 s64, s74, 0x30001
s_lshl_b32 s64, s64, 3
s_add_u32 s63, s63, s64
s_lshl_b32 s63, s63, 7
s_add_u32 s63, s63, 9502720
v_and_b32 v3, 1, v0
v_lshl_add_u32 v27, v3, 13, s63
s_lshr_b32 s65, s65, 1
s_lshl_b32 s65, s65, 7
s_lshl_b32 s64, s3, 7
s_add_u32 s64, s64, 16384
v_mov_b32 v3, s65
v_mov_b32 v4, s64
v_cmp_lt_u32 vcc, 1, v0
s_nop 1
v_cndmask_b32 v3, v3, v4, vcc
v_xor_b32 v4, 128, v4
v_cmp_lt_u32 vcc, 3, v0
s_nop 1
v_cndmask_b32 v3, v3, v4, vcc
v_add_u32 v27, v27, v3
v_mov_b32 v3, 0x80000000
v_cmp_lt_u32 vcc, 5, v0
s_nop 1
v_cndmask_b32 v27, v27, v3, vcc
s_mov_b32 s44, s18
s_mov_b32 s45, s19
s_mov_b32 s46, 256
s_mov_b32 s47, 0x20000
v_mov_b32 v28, 0
s_add_u32 s6, s66, 128
s_cmp_eq_u32 s6, 896
s_cselect_b32 s6, 0, s6
s_mul_i32 s12, s6, 1792
s_add_u32 s7, s6, 128
s_cmp_eq_u32 s7, 896
s_cselect_b32 s7, 0, s7
s_mul_i32 s13, s7, 1792
s_add_u32 s8, s7, 128
s_cmp_eq_u32 s8, 896
s_cselect_b32 s8, 0, s8
s_mul_i32 s14, s8, 1792
s_add_u32 s9, s8, 128
s_cmp_eq_u32 s9, 896
s_cselect_b32 s9, 0, s9
s_mul_i32 s15, s9, 1792
s_add_u32 s10, s9, 128
s_cmp_eq_u32 s10, 896
s_cselect_b32 s10, 0, s10
s_mul_i32 s18, s10, 1792
s_add_u32 s11, s10, 128
s_cmp_eq_u32 s11, 896
s_cselect_b32 s11, 0, s11
s_mul_i32 s19, s11, 1792
s_add_u32 m0, s69, 16384
s_nop 0
buffer_load_dwordx4 v41, s[28:31], s67 offen offset:0 lds
buffer_load_dwordx4 v42, s[28:31], s67 offen offset:1024 lds
buffer_load_dwordx4 v43, s[28:31], s67 offen offset:2048 lds
buffer_load_dwordx4 v44, s[28:31], s67 offen offset:3072 lds
WARM_F:
s_mov_b64 exec, 0
s_cmp_eq_u32 s3, 0
s_cbranch_scc1 PADF1
s_cmp_eq_u32 s3, 1
s_cbranch_scc1 PADF2
s_cmp_eq_u32 s3, 2
s_cbranch_scc1 PADF3
s_branch PADF4
BACK_F:
s_mov_b64 exec, -1
s_add_u32 m0, s69, 81920
s_nop 0
buffer_load_dwordx4 v33, s[24:27], s6 offen offset:0 lds
buffer_load_dwordx4 v34, s[24:27], s6 offen offset:1024 lds
buffer_load_dwordx4 v35, s[24:27], s6 offen offset:2048 lds
buffer_load_dwordx4 v36, s[24:27], s6 offen offset:3072 lds
s_add_u32 m0, s69, 32768
s_nop 0
buffer_load_dwordx4 v37, s[28:31], s12 offen offset:0 lds
buffer_load_dwordx4 v38, s[28:31], s12 offen offset:1024 lds
buffer_load_dwordx4 v39, s[28:31], s12 offen offset:2048 lds
buffer_load_dwordx4 v40, s[28:31], s12 offen offset:3072 lds
s_waitcnt vmcnt(12) lgkmcnt(0)
s_barrier
ds_read_b128 a[4:7], v45 offset:0
ds_read_b128 a[8:11], v45 offset:2048
ds_read_b128 a[12:15], v47 offset:0
ds_read_b128 a[16:19], v47 offset:2048
ds_read_b64_tr_b16 a[20:21], v49 offset:0
ds_read_b64_tr_b16 a[22:23], v49 offset:2048
ds_read_b64_tr_b16 a[24:25], v50 offset:0
ds_read_b64_tr_b16 a[26:27], v50 offset:2048
ds_read_b64_tr_b16 a[28:29], v51 offset:0
ds_read_b64_tr_b16 a[30:31], v51 offset:2048
ds_read_b64_tr_b16 a[32:33], v52 offset:0
ds_read_b64_tr_b16 a[34:35], v52 offset:2048
ds_read_b64_tr_b16 a[36:37], v53 offset:0
ds_read_b64_tr_b16 a[38:39], v53 offset:2048
ds_read_b64_tr_b16 a[40:41], v54 offset:0
ds_read_b64_tr_b16 a[42:43], v54 offset:2048
ds_read_b64_tr_b16 a[44:45], v55 offset:0
ds_read_b64_tr_b16 a[46:47], v55 offset:2048
s_waitcnt vmcnt(8) lgkmcnt(0)
s_barrier
v_mfma_f32_16x16x32_bf16 v[196:199], a[0:3], a[4:7], 0
ds_read_b128 a[48:51], v46 offset:0
buffer_load_dword v29, v28, s[44:47], 0 offen sc1
v_mfma_f32_16x16x32_bf16 v[200:203], a[0:3], a[8:11], 0
ds_read_b128 a[52:55], v46 offset:2048
v_mfma_f32_16x16x32_bf16 v[184:187], a[4:7], a[4:7], 0
ds_read_b128 a[56:59], v48 offset:0
v_mfma_f32_16x16x32_bf16 v[188:191], a[8:11], a[8:11], 0
s_add_u32 m0, s69, 49152
v_mfma_f32_16x16x32_bf16 v[168:171], a[20:23], a[0:3], 0
ds_read_b128 a[60:63], v48 offset:2048
v_mfma_f32_16x16x32_bf16 v[172:175], a[24:27], a[0:3], 0
v_mfma_f32_16x16x32_bf16 v[176:179], a[28:31], a[0:3], 0
ds_read_b64_tr_b16 a[64:65], v49 offset:16384
buffer_load_dwordx4 v41, s[28:31], s12 offen offset:0 lds
v_mfma_f32_16x16x32_bf16 v[180:183], a[32:35], a[0:3], 0
ds_read_b64_tr_b16 a[66:67], v49 offset:18432
v_mfma_f32_16x16x32_bf16 v[56:59], a[20:23], a[4:7], 0
v_mfma_f32_16x16x32_bf16 v[60:63], a[20:23], a[8:11], 0
ds_read_b64_tr_b16 a[68:69], v50 offset:16384
buffer_load_dwordx4 v42, s[28:31], s12 offen offset:1024 lds
v_mfma_f32_16x16x32_bf16 v[64:67], a[20:23], a[12:15], 0
ds_read_b64_tr_b16 a[70:71], v50 offset:18432
v_mfma_f32_16x16x32_bf16 v[68:71], a[20:23], a[16:19], 0
v_mfma_f32_16x16x32_bf16 v[72:75], a[24:27], a[4:7], 0
ds_read_b64_tr_b16 a[72:73], v51 offset:16384
buffer_load_dwordx4 v43, s[28:31], s12 offen offset:2048 lds
v_mfma_f32_16x16x32_bf16 v[76:79], a[24:27], a[8:11], 0
v_mfma_f32_16x16x32_bf16 v[80:83], a[24:27], a[12:15], 0
ds_read_b64_tr_b16 a[74:75], v51 offset:18432
v_mfma_f32_16x16x32_bf16 v[84:87], a[24:27], a[16:19], 0
ds_read_b64_tr_b16 a[76:77], v52 offset:16384
v_mfma_f32_16x16x32_bf16 v[88:91], a[28:31], a[4:7], 0
buffer_load_dwordx4 v44, s[28:31], s12 offen offset:3072 lds
v_mfma_f32_16x16x32_bf16 v[92:95], a[28:31], a[8:11], 0
ds_read_b64_tr_b16 a[78:79], v52 offset:18432
v_mfma_f32_16x16x32_bf16 v[96:99], a[28:31], a[12:15], 0
ds_read_b64_tr_b16 a[80:81], v53 offset:16384
v_mfma_f32_16x16x32_bf16 v[100:103], a[28:31], a[16:19], 0
s_add_u32 m0, s69, 98304
v_mfma_f32_16x16x32_bf16 v[104:107], a[32:35], a[4:7], 0
ds_read_b64_tr_b16 a[82:83], v53 offset:18432
v_mfma_f32_16x16x32_bf16 v[108:111], a[32:35], a[8:11], 0
v_mfma_f32_16x16x32_bf16 v[112:115], a[32:35], a[12:15], 0
ds_read_b64_tr_b16 a[84:85], v54 offset:16384
buffer_load_dwordx4 v33, s[24:27], s7 offen offset:0 lds
v_mfma_f32_16x16x32_bf16 v[116:119], a[32:35], a[16:19], 0
ds_read_b64_tr_b16 a[86:87], v54 offset:18432
v_mfma_f32_16x16x32_bf16 v[120:123], a[36:39], a[4:7], 0
v_mfma_f32_16x16x32_bf16 v[124:127], a[36:39], a[8:11], 0
ds_read_b64_tr_b16 a[88:89], v55 offset:16384
buffer_load_dwordx4 v34, s[24:27], s7 offen offset:1024 lds
v_mfma_f32_16x16x32_bf16 v[128:131], a[36:39], a[12:15], 0
ds_read_b64_tr_b16 a[90:91], v55 offset:18432
v_mfma_f32_16x16x32_bf16 v[132:135], a[36:39], a[16:19], 0
v_mfma_f32_16x16x32_bf16 v[136:139], a[40:43], a[4:7], 0
buffer_load_dwordx4 v35, s[24:27], s7 offen offset:2048 lds
v_mfma_f32_16x16x32_bf16 v[140:143], a[40:43], a[8:11], 0
v_mfma_f32_16x16x32_bf16 v[144:147], a[40:43], a[12:15], 0
v_mfma_f32_16x16x32_bf16 v[148:151], a[40:43], a[16:19], 0
buffer_load_dwordx4 v36, s[24:27], s7 offen offset:3072 lds
v_mfma_f32_16x16x32_bf16 v[152:155], a[44:47], a[4:7], 0
v_mfma_f32_16x16x32_bf16 v[156:159], a[44:47], a[8:11], 0
v_mfma_f32_16x16x32_bf16 v[160:163], a[44:47], a[12:15], 0
v_mfma_f32_16x16x32_bf16 v[164:167], a[44:47], a[16:19], 0
s_waitcnt vmcnt(9) lgkmcnt(0)
s_barrier
v_mfma_f32_16x16x32_bf16 v[196:199], a[0:3], a[48:51], v[196:199]
ds_read_b128 a[4:7], v45 offset:16384
s_add_u32 m0, s69, 0
v_mfma_f32_16x16x32_bf16 v[200:203], a[0:3], a[52:55], v[200:203]
ds_read_b128 a[8:11], v45 offset:18432
v_mfma_f32_16x16x32_bf16 v[184:187], a[48:51], a[48:51], v[184:187]
ds_read_b128 a[12:15], v47 offset:16384
v_mfma_f32_16x16x32_bf16 v[188:191], a[52:55], a[52:55], v[188:191]
v_mfma_f32_16x16x32_bf16 v[168:171], a[64:67], a[0:3], v[168:171]
buffer_load_dwordx4 v37, s[28:31], s13 offen offset:0 lds
ds_read_b128 a[16:19], v47 offset:18432
v_mfma_f32_16x16x32_bf16 v[172:175], a[68:71], a[0:3], v[172:175]
v_mfma_f32_16x16x32_bf16 v[176:179], a[72:75], a[0:3], v[176:179]
ds_read_b64_tr_b16 a[20:21], v49 offset:32768
v_mfma_f32_16x16x32_bf16 v[180:183], a[76:79], a[0:3], v[180:183]
buffer_load_dwordx4 v38, s[28:31], s13 offen offset:1024 lds
ds_read_b64_tr_b16 a[22:23], v49 offset:34816
v_mfma_f32_16x16x32_bf16 v[56:59], a[64:67], a[48:51], v[56:59]
v_mfma_f32_16x16x32_bf16 v[60:63], a[64:67], a[52:55], v[60:63]
ds_read_b64_tr_b16 a[24:25], v50 offset:32768
v_mfma_f32_16x16x32_bf16 v[64:67], a[64:67], a[56:59], v[64:67]
buffer_load_dwordx4 v39, s[28:31], s13 offen offset:2048 lds
ds_read_b64_tr_b16 a[26:27], v50 offset:34816
v_mfma_f32_16x16x32_bf16 v[68:71], a[64:67], a[60:63], v[68:71]
v_mfma_f32_16x16x32_bf16 v[72:75], a[68:71], a[48:51], v[72:75]
ds_read_b64_tr_b16 a[28:29], v51 offset:32768
v_mfma_f32_16x16x32_bf16 v[76:79], a[68:71], a[52:55], v[76:79]
v_mfma_f32_16x16x32_bf16 v[80:83], a[68:71], a[56:59], v[80:83]
ds_read_b64_tr_b16 a[30:31], v51 offset:34816
buffer_load_dwordx4 v40, s[28:31], s13 offen offset:3072 lds
v_mfma_f32_16x16x32_bf16 v[84:87], a[68:71], a[60:63], v[84:87]
ds_read_b64_tr_b16 a[32:33], v52 offset:32768
v_mfma_f32_16x16x32_bf16 v[88:91], a[72:75], a[48:51], v[88:91]
v_mfma_f32_16x16x32_bf16 v[92:95], a[72:75], a[52:55], v[92:95]
ds_read_b64_tr_b16 a[34:35], v52 offset:34816
s_add_u32 m0, s69, 16384
v_mfma_f32_16x16x32_bf16 v[96:99], a[72:75], a[56:59], v[96:99]
ds_read_b64_tr_b16 a[36:37], v53 offset:32768
v_mfma_f32_16x16x32_bf16 v[100:103], a[72:75], a[60:63], v[100:103]
v_mfma_f32_16x16x32_bf16 v[104:107], a[76:79], a[48:51], v[104:107]
ds_read_b64_tr_b16 a[38:39], v53 offset:34816
v_mfma_f32_16x16x32_bf16 v[108:111], a[76:79], a[52:55], v[108:111]
buffer_load_dwordx4 v41, s[28:31], s13 offen offset:0 lds
v_mfma_f32_16x16x32_bf16 v[112:115], a[76:79], a[56:59], v[112:115]
ds_read_b64_tr_b16 a[40:41], v54 offset:32768
v_mfma_f32_16x16x32_bf16 v[116:119], a[76:79], a[60:63], v[116:119]
ds_read_b64_tr_b16 a[42:43], v54 offset:34816
v_mfma_f32_16x16x32_bf16 v[120:123], a[80:83], a[48:51], v[120:123]
buffer_load_dwordx4 v42, s[28:31], s13 offen offset:1024 lds
v_mfma_f32_16x16x32_bf16 v[124:127], a[80:83], a[52:55], v[124:127]
ds_read_b64_tr_b16 a[44:45], v55 offset:32768
v_mfma_f32_16x16x32_bf16 v[128:131], a[80:83], a[56:59], v[128:131]
ds_read_b64_tr_b16 a[46:47], v55 offset:34816
v_mfma_f32_16x16x32_bf16 v[132:135], a[80:83], a[60:63], v[132:135]
v_mfma_f32_16x16x32_bf16 v[136:139], a[84:87], a[48:51], v[136:139]
buffer_load_dwordx4 v43, s[28:31], s13 offen offset:2048 lds
v_mfma_f32_16x16x32_bf16 v[140:143], a[84:87], a[52:55], v[140:143]
v_mfma_f32_16x16x32_bf16 v[144:147], a[84:87], a[56:59], v[144:147]
v_mfma_f32_16x16x32_bf16 v[148:151], a[84:87], a[60:63], v[148:151]
buffer_load_dwordx4 v44, s[28:31], s13 offen offset:3072 lds
v_mfma_f32_16x16x32_bf16 v[152:155], a[88:91], a[48:51], v[152:155]
v_mfma_f32_16x16x32_bf16 v[156:159], a[88:91], a[52:55], v[156:159]
v_mfma_f32_16x16x32_bf16 v[160:163], a[88:91], a[56:59], v[160:163]
v_mfma_f32_16x16x32_bf16 v[164:167], a[88:91], a[60:63], v[164:167]
s_waitcnt vmcnt(12) lgkmcnt(0)
s_barrier
v_mfma_f32_16x16x32_bf16 v[56:59], a[20:23], a[4:7], v[56:59]
ds_read_b128 a[48:51], v46 offset:16384
s_add_u32 m0, s69, 65536
v_mfma_f32_16x16x32_bf16 v[60:63], a[20:23], a[8:11], v[60:63]
ds_read_b128 a[52:55], v46 offset:18432
v_mfma_f32_16x16x32_bf16 v[64:67], a[20:23], a[12:15], v[64:67]
ds_read_b128 a[56:59], v48 offset:16384
buffer_load_dwordx4 v33, s[24:27], s8 offen offset:0 lds
v_mfma_f32_16x16x32_bf16 v[68:71], a[20:23], a[16:19], v[68:71]
ds_read_b128 a[60:63], v48 offset:18432
v_mfma_f32_16x16x32_bf16 v[72:75], a[24:27], a[4:7], v[72:75]
ds_read_b64_tr_b16 a[64:65], v49 offset:49152
v_mfma_f32_16x16x32_bf16 v[76:79], a[24:27], a[8:11], v[76:79]
buffer_load_dwordx4 v34, s[24:27], s8 offen offset:1024 lds
ds_read_b64_tr_b16 a[66:67], v49 offset:51200
v_mfma_f32_16x16x32_bf16 v[80:83], a[24:27], a[12:15], v[80:83]
s_waitcnt vmcnt(18)
v_readfirstlane_b32 s86, v29
s_nop 0
s_cmp_eq_u32 s86, 0
s_cbranch_scc1 TAGSL_F
TAGOK_F:
v_mfma_f32_16x16x32_bf16 v[84:87], a[24:27], a[16:19], v[84:87]
v_cndmask_b32 v168, v168, v169, s[56:57]
v_cndmask_b32 v170, v170, v171, s[56:57]
v_mfma_f32_16x16x32_bf16 v[88:91], a[28:31], a[4:7], v[88:91]
ds_read_b64_tr_b16 a[68:69], v50 offset:49152
v_cndmask_b32 v168, v168, v170, s[58:59]
v_mfma_f32_16x16x32_bf16 v[92:95], a[28:31], a[8:11], v[92:95]
buffer_load_dwordx4 v35, s[24:27], s8 offen offset:2048 lds
ds_read_b64_tr_b16 a[70:71], v50 offset:51200
v_mfma_f32_16x16x32_bf16 v[96:99], a[28:31], a[12:15], v[96:99]
ds_read_b64_tr_b16 a[72:73], v51 offset:49152
v_cndmask_b32 v172, v172, v173, s[56:57]
v_mfma_f32_16x16x32_bf16 v[100:103], a[28:31], a[16:19], v[100:103]
ds_read_b64_tr_b16 a[74:75], v51 offset:51200
buffer_load_dwordx4 v36, s[24:27], s8 offen offset:3072 lds
v_mfma_f32_16x16x32_bf16 v[104:107], a[32:35], a[4:7], v[104:107]
v_cndmask_b32 v174, v174, v175, s[56:57]
v_cndmask_b32 v172, v172, v174, s[58:59]
v_mfma_f32_16x16x32_bf16 v[108:111], a[32:35], a[8:11], v[108:111]
ds_read_b64_tr_b16 a[76:77], v52 offset:49152
v_cndmask_b32 v176, v176, v177, s[56:57]
v_mfma_f32_16x16x32_bf16 v[112:115], a[32:35], a[12:15], v[112:115]
ds_read_b64_tr_b16 a[78:79], v52 offset:51200
s_add_u32 m0, s69, 32768
v_mfma_f32_16x16x32_bf16 v[116:119], a[32:35], a[16:19], v[116:119]
ds_read_b64_tr_b16 a[80:81], v53 offset:49152
v_cndmask_b32 v178, v178, v179, s[56:57]
v_mfma_f32_16x16x32_bf16 v[120:123], a[36:39], a[4:7], v[120:123]
ds_read_b64_tr_b16 a[82:83], v53 offset:51200
v_cndmask_b32 v176, v176, v178, s[58:59]
v_mfma_f32_16x16x32_bf16 v[124:127], a[36:39], a[8:11], v[124:127]
buffer_load_dwordx4 v37, s[28:31], s14 offen offset:0 lds
ds_read_b64_tr_b16 a[84:85], v54 offset:49152
v_mfma_f32_16x16x32_bf16 v[128:131], a[36:39], a[12:15], v[128:131]
v_cndmask_b32 v180, v180, v181, s[56:57]
v_cndmask_b32 v182, v182, v183, s[56:57]
v_mfma_f32_16x16x32_bf16 v[132:135], a[36:39], a[16:19], v[132:135]
ds_read_b64_tr_b16 a[86:87], v54 offset:51200
buffer_load_dwordx4 v38, s[28:31], s14 offen offset:1024 lds
v_mfma_f32_16x16x32_bf16 v[136:139], a[40:43], a[4:7], v[136:139]
ds_read_b64_tr_b16 a[88:89], v55 offset:49152
v_cndmask_b32 v180, v180, v182, s[58:59]
v_mfma_f32_16x16x32_bf16 v[140:143], a[40:43], a[8:11], v[140:143]
ds_read_b64_tr_b16 a[90:91], v55 offset:51200
buffer_load_dwordx4 v39, s[28:31], s14 offen offset:2048 lds
v_mfma_f32_16x16x32_bf16 v[144:147], a[40:43], a[12:15], v[144:147]
v_mfma_f32_16x16x32_bf16 v[148:151], a[40:43], a[16:19], v[148:151]
v_mfma_f32_16x16x32_bf16 v[152:155], a[44:47], a[4:7], v[152:155]
buffer_load_dwordx4 v40, s[28:31], s14 offen offset:3072 lds
v_mfma_f32_16x16x32_bf16 v[156:159], a[44:47], a[8:11], v[156:159]
v_mfma_f32_16x16x32_bf16 v[160:163], a[44:47], a[12:15], v[160:163]
v_mfma_f32_16x16x32_bf16 v[164:167], a[44:47], a[16:19], v[164:167]
s_waitcnt vmcnt(12) lgkmcnt(0)
s_barrier
v_mfma_f32_16x16x32_bf16 v[56:59], a[64:67], a[48:51], v[56:59]
ds_read_b128 a[4:7], v45 offset:32768
s_add_u32 m0, s69, 49152
v_mfma_f32_16x16x32_bf16 v[60:63], a[64:67], a[52:55], v[60:63]
ds_read_b128 a[8:11], v45 offset:34816
v_cndmask_b32 v168, v168, v172, s[52:53]
v_mfma_f32_16x16x32_bf16 v[64:67], a[64:67], a[56:59], v[64:67]
ds_read_b128 a[12:15], v47 offset:32768
v_cndmask_b32 v176, v176, v180, s[52:53]
v_mfma_f32_16x16x32_bf16 v[68:71], a[64:67], a[60:63], v[68:71]
v_cndmask_b32 v168, v168, v176, s[54:55]
v_mfma_f32_16x16x32_bf16 v[72:75], a[68:71], a[48:51], v[72:75]
ds_read_b128 a[16:19], v47 offset:34816
buffer_load_dwordx4 v41, s[28:31], s14 offen offset:0 lds
v_mfma_f32_16x16x32_bf16 v[76:79], a[68:71], a[52:55], v[76:79]
ds_read_b64_tr_b16 a[20:21], v49 offset:0
v_mov_b32 v169, s86
v_mfma_f32_16x16x32_bf16 v[80:83], a[68:71], a[56:59], v[80:83]
buffer_store_dwordx2 v[168:169], v212, s[32:35], 0 offen sc1
ds_read_b64_tr_b16 a[22:23], v49 offset:2048
v_mfma_f32_16x16x32_bf16 v[84:87], a[68:71], a[60:63], v[84:87]
v_cmp_eq_u32 vcc, 1, v205
v_mov_b32 v197, s86
v_mfma_f32_16x16x32_bf16 v[88:91], a[72:75], a[48:51], v[88:91]
ds_read_b64_tr_b16 a[24:25], v50 offset:0
buffer_load_dwordx4 v42, s[28:31], s14 offen offset:1024 lds
v_mfma_f32_16x16x32_bf16 v[92:95], a[72:75], a[52:55], v[92:95]
ds_read_b64_tr_b16 a[26:27], v50 offset:2048
v_cndmask_b32 v196, v196, v200, vcc
v_mfma_f32_16x16x32_bf16 v[96:99], a[72:75], a[56:59], v[96:99]
ds_read_b64_tr_b16 a[28:29], v51 offset:0
buffer_store_dwordx2 v[196:197], v213, s[32:35], 0 offen sc1
v_mfma_f32_16x16x32_bf16 v[100:103], a[72:75], a[60:63], v[100:103]
buffer_load_dwordx4 v43, s[28:31], s14 offen offset:2048 lds
ds_read_b64_tr_b16 a[30:31], v51 offset:2048
v_mfma_f32_16x16x32_bf16 v[104:107], a[76:79], a[48:51], v[104:107]
v_cndmask_b32 v184, v184, v185, s[56:57]
v_cndmask_b32 v186, v186, v187, s[56:57]
v_mfma_f32_16x16x32_bf16 v[108:111], a[76:79], a[52:55], v[108:111]
ds_read_b64_tr_b16 a[32:33], v52 offset:0
v_cndmask_b32 v188, v188, v189, s[56:57]
v_mfma_f32_16x16x32_bf16 v[112:115], a[76:79], a[56:59], v[112:115]
ds_read_b64_tr_b16 a[34:35], v52 offset:2048
buffer_load_dwordx4 v44, s[28:31], s14 offen offset:3072 lds
v_mfma_f32_16x16x32_bf16 v[116:119], a[76:79], a[60:63], v[116:119]
ds_read_b64_tr_b16 a[36:37], v53 offset:0
v_cndmask_b32 v190, v190, v191, s[56:57]
v_mfma_f32_16x16x32_bf16 v[120:123], a[80:83], a[48:51], v[120:123]
ds_read_b64_tr_b16 a[38:39], v53 offset:2048
v_cndmask_b32 v184, v184, v186, s[58:59]
v_mfma_f32_16x16x32_bf16 v[124:127], a[80:83], a[52:55], v[124:127]
ds_read_b64_tr_b16 a[40:41], v54 offset:0
s_add_u32 m0, s69, 81920
v_mfma_f32_16x16x32_bf16 v[128:131], a[80:83], a[56:59], v[128:131]
v_cndmask_b32 v186, v188, v190, s[58:59]
v_mov_b32 v185, s86
v_mfma_f32_16x16x32_bf16 v[132:135], a[80:83], a[60:63], v[132:135]
ds_read_b64_tr_b16 a[42:43], v54 offset:2048
v_mov_b32 v187, s86
v_mfma_f32_16x16x32_bf16 v[136:139], a[84:87], a[48:51], v[136:139]
ds_read_b64_tr_b16 a[44:45], v55 offset:0
PADF1:
s_cbranch_execz BACK_F
buffer_load_dwordx4 v33, s[24:27], s9 offen offset:0 lds
v_mfma_f32_16x16x32_bf16 v[140:143], a[84:87], a[52:55], v[140:143]
ds_read_b64_tr_b16 a[46:47], v55 offset:2048
buffer_store_dwordx4 v[184:187], v217, s[32:35], 0 offen offset:256 sc1
v_mfma_f32_16x16x32_bf16 v[144:147], a[84:87], a[56:59], v[144:147]
v_mfma_f32_16x16x32_bf16 v[148:151], a[84:87], a[60:63], v[148:151]
buffer_load_dwordx4 v34, s[24:27], s9 offen offset:1024 lds
v_mfma_f32_16x16x32_bf16 v[152:155], a[88:91], a[48:51], v[152:155]
v_mfma_f32_16x16x32_bf16 v[156:159], a[88:91], a[52:55], v[156:159]
v_mfma_f32_16x16x32_bf16 v[160:163], a[88:91], a[56:59], v[160:163]
v_mfma_f32_16x16x32_bf16 v[164:167], a[88:91], a[60:63], v[164:167]
s_waitcnt vmcnt(17) lgkmcnt(0)
s_barrier
v_mfma_f32_16x16x32_bf16 v[56:59], a[20:23], a[4:7], v[56:59]
ds_read_b128 a[48:51], v46 offset:32768
s_add_u32 m0, s69, 81920
v_mfma_f32_16x16x32_bf16 v[60:63], a[20:23], a[8:11], v[60:63]
ds_read_b128 a[52:55], v46 offset:34816
v_mfma_f32_16x16x32_bf16 v[64:67], a[20:23], a[12:15], v[64:67]
ds_read_b128 a[56:59], v48 offset:32768
v_mfma_f32_16x16x32_bf16 v[68:71], a[20:23], a[16:19], v[68:71]
ds_read_b128 a[60:63], v48 offset:34816
buffer_load_dwordx4 v35, s[24:27], s9 offen offset:2048 lds
v_mfma_f32_16x16x32_bf16 v[72:75], a[24:27], a[4:7], v[72:75]
ds_read_b64_tr_b16 a[64:65], v49 offset:16384
v_mfma_f32_16x16x32_bf16 v[76:79], a[24:27], a[8:11], v[76:79]
ds_read_b64_tr_b16 a[66:67], v49 offset:18432
v_mfma_f32_16x16x32_bf16 v[80:83], a[24:27], a[12:15], v[80:83]
v_mfma_f32_16x16x32_bf16 v[84:87], a[24:27], a[16:19], v[84:87]
ds_read_b64_tr_b16 a[68:69], v50 offset:16384
buffer_load_dwordx4 v36, s[24:27], s9 offen offset:3072 lds
v_mfma_f32_16x16x32_bf16 v[88:91], a[28:31], a[4:7], v[88:91]
ds_read_b64_tr_b16 a[70:71], v50 offset:18432
v_mfma_f32_16x16x32_bf16 v[92:95], a[28:31], a[8:11], v[92:95]
ds_read_b64_tr_b16 a[72:73], v51 offset:16384
v_mfma_f32_16x16x32_bf16 v[96:99], a[28:31], a[12:15], v[96:99]
s_add_u32 m0, s69, 0
ds_read_b64_tr_b16 a[74:75], v51 offset:18432
v_mfma_f32_16x16x32_bf16 v[100:103], a[28:31], a[16:19], v[100:103]
v_mfma_f32_16x16x32_bf16 v[104:107], a[32:35], a[4:7], v[104:107]
ds_read_b64_tr_b16 a[76:77], v52 offset:16384
v_mfma_f32_16x16x32_bf16 v[108:111], a[32:35], a[8:11], v[108:111]
ds_read_b64_tr_b16 a[78:79], v52 offset:18432
buffer_load_dwordx4 v37, s[28:31], s15 offen offset:0 lds
v_mfma_f32_16x16x32_bf16 v[112:115], a[32:35], a[12:15], v[112:115]
ds_read_b64_tr_b16 a[80:81], v53 offset:16384
v_mfma_f32_16x16x32_bf16 v[116:119], a[32:35], a[16:19], v[116:119]
ds_read_b64_tr_b16 a[82:83], v53 offset:18432
v_mfma_f32_16x16x32_bf16 v[120:123], a[36:39], a[4:7], v[120:123]
v_mfma_f32_16x16x32_bf16 v[124:127], a[36:39], a[8:11], v[124:127]
ds_read_b64_tr_b16 a[84:85], v54 offset:16384
buffer_load_dwordx4 v38, s[28:31], s15 offen offset:1024 lds
v_mfma_f32_16x16x32_bf16 v[128:131], a[36:39], a[12:15], v[128:131]
ds_read_b64_tr_b16 a[86:87], v54 offset:18432
v_mfma_f32_16x16x32_bf16 v[132:135], a[36:39], a[16:19], v[132:135]
ds_read_b64_tr_b16 a[88:89], v55 offset:16384
v_mfma_f32_16x16x32_bf16 v[136:139], a[40:43], a[4:7], v[136:139]
buffer_load_dwordx4 v39, s[28:31], s15 offen offset:2048 lds
ds_read_b64_tr_b16 a[90:91], v55 offset:18432
v_mfma_f32_16x16x32_bf16 v[140:143], a[40:43], a[8:11], v[140:143]
v_mfma_f32_16x16x32_bf16 v[144:147], a[40:43], a[12:15], v[144:147]
v_mfma_f32_16x16x32_bf16 v[148:151], a[40:43], a[16:19], v[148:151]
buffer_load_dwordx4 v40, s[28:31], s15 offen offset:3072 lds
v_mfma_f32_16x16x32_bf16 v[152:155], a[44:47], a[4:7], v[152:155]
v_mfma_f32_16x16x32_bf16 v[156:159], a[44:47], a[8:11], v[156:159]
v_mfma_f32_16x16x32_bf16 v[160:163], a[44:47], a[12:15], v[160:163]
v_mfma_f32_16x16x32_bf16 v[164:167], a[44:47], a[16:19], v[164:167]
s_waitcnt vmcnt(15) lgkmcnt(0)
s_barrier
v_mfma_f32_16x16x32_bf16 v[56:59], a[64:67], a[48:51], v[56:59]
ds_read_b128 a[4:7], v45 offset:0
s_add_u32 m0, s69, 16384
v_mfma_f32_16x16x32_bf16 v[60:63], a[64:67], a[52:55], v[60:63]
ds_read_b128 a[8:11], v45 offset:2048
v_mfma_f32_16x16x32_bf16 v[64:67], a[64:67], a[56:59], v[64:67]
ds_read_b128 a[12:15], v47 offset:0
v_mfma_f32_16x16x32_bf16 v[68:71], a[64:67], a[60:63], v[68:71]
ds_read_b128 a[16:19], v47 offset:2048
buffer_load_dwordx4 v41, s[28:31], s15 offen offset:0 lds
v_mfma_f32_16x16x32_bf16 v[72:75], a[68:71], a[48:51], v[72:75]
ds_read_b64_tr_b16 a[20:21], v49 offset:32768
v_mfma_f32_16x16x32_bf16 v[76:79], a[68:71], a[52:55], v[76:79]
ds_read_b64_tr_b16 a[22:23], v49 offset:34816
v_mfma_f32_16x16x32_bf16 v[80:83], a[68:71], a[56:59], v[80:83]
v_mfma_f32_16x16x32_bf16 v[84:87], a[68:71], a[60:63], v[84:87]
ds_read_b64_tr_b16 a[24:25], v50 offset:32768
buffer_load_dwordx4 v42, s[28:31], s15 offen offset:1024 lds
v_mfma_f32_16x16x32_bf16 v[88:91], a[72:75], a[48:51], v[88:91]
ds_read_b64_tr_b16 a[26:27], v50 offset:34816
v_mfma_f32_16x16x32_bf16 v[92:95], a[72:75], a[52:55], v[92:95]
ds_read_b64_tr_b16 a[28:29], v51 offset:32768
v_mfma_f32_16x16x32_bf16 v[96:99], a[72:75], a[56:59], v[96:99]
buffer_load_dwordx4 v43, s[28:31], s15 offen offset:2048 lds
ds_read_b64_tr_b16 a[30:31], v51 offset:34816
v_mfma_f32_16x16x32_bf16 v[100:103], a[72:75], a[60:63], v[100:103]
v_mfma_f32_16x16x32_bf16 v[104:107], a[76:79], a[48:51], v[104:107]
ds_read_b64_tr_b16 a[32:33], v52 offset:32768
v_mfma_f32_16x16x32_bf16 v[108:111], a[76:79], a[52:55], v[108:111]
ds_read_b64_tr_b16 a[34:35], v52 offset:34816
buffer_load_dwordx4 v44, s[28:31], s15 offen offset:3072 lds
v_mfma_f32_16x16x32_bf16 v[112:115], a[76:79], a[56:59], v[112:115]
ds_read_b64_tr_b16 a[36:37], v53 offset:32768
v_mfma_f32_16x16x32_bf16 v[116:119], a[76:79], a[60:63], v[116:119]
ds_read_b64_tr_b16 a[38:39], v53 offset:34816
v_mfma_f32_16x16x32_bf16 v[120:123], a[80:83], a[48:51], v[120:123]
v_mfma_f32_16x16x32_bf16 v[124:127], a[80:83], a[52:55], v[124:127]
ds_read_b64_tr_b16 a[40:41], v54 offset:32768
s_add_u32 m0, s69, 98304
v_mfma_f32_16x16x32_bf16 v[128:131], a[80:83], a[56:59], v[128:131]
ds_read_b64_tr_b16 a[42:43], v54 offset:34816
v_mfma_f32_16x16x32_bf16 v[132:135], a[80:83], a[60:63], v[132:135]
ds_read_b64_tr_b16 a[44:45], v55 offset:32768
v_mfma_f32_16x16x32_bf16 v[136:139], a[84:87], a[48:51], v[136:139]
buffer_load_dwordx4 v33, s[24:27], s10 offen offset:0 lds
ds_read_b64_tr_b16 a[46:47], v55 offset:34816
v_mfma_f32_16x16x32_bf16 v[140:143], a[84:87], a[52:55], v[140:143]
v_mfma_f32_16x16x32_bf16 v[144:147], a[84:87], a[56:59], v[144:147]
v_mfma_f32_16x16x32_bf16 v[148:151], a[84:87], a[60:63], v[148:151]
buffer_load_dwordx4 v34, s[24:27], s10 offen offset:1024 lds
v_mfma_f32_16x16x32_bf16 v[152:155], a[88:91], a[48:51], v[152:155]
v_mfma_f32_16x16x32_bf16 v[156:159], a[88:91], a[52:55], v[156:159]
v_mfma_f32_16x16x32_bf16 v[160:163], a[88:91], a[56:59], v[160:163]
v_mfma_f32_16x16x32_bf16 v[164:167], a[88:91], a[60:63], v[164:167]
s_waitcnt vmcnt(15) lgkmcnt(0)
s_barrier
v_mfma_f32_16x16x32_bf16 v[56:59], a[20:23], a[4:7], v[56:59]
ds_read_b128 a[48:51], v46 offset:0
s_add_u32 m0, s69, 98304
v_mfma_f32_16x16x32_bf16 v[60:63], a[20:23], a[8:11], v[60:63]
ds_read_b128 a[52:55], v46 offset:2048
v_mfma_f32_16x16x32_bf16 v[64:67], a[20:23], a[12:15], v[64:67]
ds_read_b128 a[56:59], v48 offset:0
v_mfma_f32_16x16x32_bf16 v[68:71], a[20:23], a[16:19], v[68:71]
ds_read_b128 a[60:63], v48 offset:2048
buffer_load_dwordx4 v35, s[24:27], s10 offen offset:2048 lds
v_mfma_f32_16x16x32_bf16 v[72:75], a[24:27], a[4:7], v[72:75]
ds_read_b64_tr_b16 a[64:65], v49 offset:49152
v_mfma_f32_16x16x32_bf16 v[76:79], a[24:27], a[8:11], v[76:79]
ds_read_b64_tr_b16 a[66:67], v49 offset:51200
v_mfma_f32_16x16x32_bf16 v[80:83], a[24:27], a[12:15], v[80:83]
v_mfma_f32_16x16x32_bf16 v[84:87], a[24:27], a[16:19], v[84:87]
ds_read_b64_tr_b16 a[68:69], v50 offset:49152
buffer_load_dwordx4 v36, s[24:27], s10 offen offset:3072 lds
v_mfma_f32_16x16x32_bf16 v[88:91], a[28:31], a[4:7], v[88:91]
ds_read_b64_tr_b16 a[70:71], v50 offset:51200
v_mfma_f32_16x16x32_bf16 v[92:95], a[28:31], a[8:11], v[92:95]
ds_read_b64_tr_b16 a[72:73], v51 offset:49152
v_mfma_f32_16x16x32_bf16 v[96:99], a[28:31], a[12:15], v[96:99]
s_add_u32 m0, s69, 32768
ds_read_b64_tr_b16 a[74:75], v51 offset:51200
v_mfma_f32_16x16x32_bf16 v[100:103], a[28:31], a[16:19], v[100:103]
v_mfma_f32_16x16x32_bf16 v[104:107], a[32:35], a[4:7], v[104:107]
ds_read_b64_tr_b16 a[76:77], v52 offset:49152
v_mfma_f32_16x16x32_bf16 v[108:111], a[32:35], a[8:11], v[108:111]
ds_read_b64_tr_b16 a[78:79], v52 offset:51200
buffer_load_dwordx4 v37, s[28:31], s18 offen offset:0 lds
v_mfma_f32_16x16x32_bf16 v[112:115], a[32:35], a[12:15], v[112:115]
ds_read_b64_tr_b16 a[80:81], v53 offset:49152
v_mfma_f32_16x16x32_bf16 v[116:119], a[32:35], a[16:19], v[116:119]
ds_read_b64_tr_b16 a[82:83], v53 offset:51200
v_mfma_f32_16x16x32_bf16 v[120:123], a[36:39], a[4:7], v[120:123]
v_mfma_f32_16x16x32_bf16 v[124:127], a[36:39], a[8:11], v[124:127]
ds_read_b64_tr_b16 a[84:85], v54 offset:49152
buffer_load_dwordx4 v38, s[28:31], s18 offen offset:1024 lds
v_mfma_f32_16x16x32_bf16 v[128:131], a[36:39], a[12:15], v[128:131]
ds_read_b64_tr_b16 a[86:87], v54 offset:51200
v_mfma_f32_16x16x32_bf16 v[132:135], a[36:39], a[16:19], v[132:135]
ds_read_b64_tr_b16 a[88:89], v55 offset:49152
v_mfma_f32_16x16x32_bf16 v[136:139], a[40:43], a[4:7], v[136:139]
buffer_load_dwordx4 v39, s[28:31], s18 offen offset:2048 lds
ds_read_b64_tr_b16 a[90:91], v55 offset:51200
v_mfma_f32_16x16x32_bf16 v[140:143], a[40:43], a[8:11], v[140:143]
v_mfma_f32_16x16x32_bf16 v[144:147], a[40:43], a[12:15], v[144:147]
v_mfma_f32_16x16x32_bf16 v[148:151], a[40:43], a[16:19], v[148:151]
buffer_load_dwordx4 v40, s[28:31], s18 offen offset:3072 lds
v_mfma_f32_16x16x32_bf16 v[152:155], a[44:47], a[4:7], v[152:155]
v_mfma_f32_16x16x32_bf16 v[156:159], a[44:47], a[8:11], v[156:159]
v_mfma_f32_16x16x32_bf16 v[160:163], a[44:47], a[12:15], v[160:163]
v_mfma_f32_16x16x32_bf16 v[164:167], a[44:47], a[16:19], v[164:167]
s_waitcnt vmcnt(12) lgkmcnt(0)
s_barrier
v_mfma_f32_16x16x32_bf16 v[56:59], a[64:67], a[48:51], v[56:59]
ds_read_b128 a[4:7], v45 offset:16384
s_add_u32 m0, s69, 49152
v_mfma_f32_16x16x32_bf16 v[60:63], a[64:67], a[52:55], v[60:63]
ds_read_b128 a[8:11], v45 offset:18432
v_mfma_f32_16x16x32_bf16 v[64:67], a[64:67], a[56:59], v[64:67]
ds_read_b128 a[12:15], v47 offset:16384
v_mfma_f32_16x16x32_bf16 v[68:71], a[64:67], a[60:63], v[68:71]
ds_read_b128 a[16:19], v47 offset:18432
buffer_load_dwordx4 v41, s[28:31], s18 offen offset:0 lds
v_mfma_f32_16x16x32_bf16 v[72:75], a[68:71], a[48:51], v[72:75]
ds_read_b64_tr_b16 a[20:21], v49 offset:0
v_mfma_f32_16x16x32_bf16 v[76:79], a[68:71], a[52:55], v[76:79]
ds_read_b64_tr_b16 a[22:23], v49 offset:2048
v_mfma_f32_16x16x32_bf16 v[80:83], a[68:71], a[56:59], v[80:83]
v_mfma_f32_16x16x32_bf16 v[84:87], a[68:71], a[60:63], v[84:87]
ds_read_b64_tr_b16 a[24:25], v50 offset:0
buffer_load_dwordx4 v42, s[28:31], s18 offen offset:1024 lds
v_mfma_f32_16x16x32_bf16 v[88:91], a[72:75], a[48:51], v[88:91]
ds_read_b64_tr_b16 a[26:27], v50 offset:2048
v_mfma_f32_16x16x32_bf16 v[92:95], a[72:75], a[52:55], v[92:95]
ds_read_b64_tr_b16 a[28:29], v51 offset:0
v_mfma_f32_16x16x32_bf16 v[96:99], a[72:75], a[56:59], v[96:99]
buffer_load_dwordx4 v43, s[28:31], s18 offen offset:2048 lds
ds_read_b64_tr_b16 a[30:31], v51 offset:2048
v_mfma_f32_16x16x32_bf16 v[100:103], a[72:75], a[60:63], v[100:103]
v_mfma_f32_16x16x32_bf16 v[104:107], a[76:79], a[48:51], v[104:107]
ds_read_b64_tr_b16 a[32:33], v52 offset:0
v_mfma_f32_16x16x32_bf16 v[108:111], a[76:79], a[52:55], v[108:111]
ds_read_b64_tr_b16 a[34:35], v52 offset:2048
buffer_load_dwordx4 v44, s[28:31], s18 offen offset:3072 lds
v_mfma_f32_16x16x32_bf16 v[112:115], a[76:79], a[56:59], v[112:115]
ds_read_b64_tr_b16 a[36:37], v53 offset:0
v_mfma_f32_16x16x32_bf16 v[116:119], a[76:79], a[60:63], v[116:119]
ds_read_b64_tr_b16 a[38:39], v53 offset:2048
v_mfma_f32_16x16x32_bf16 v[120:123], a[80:83], a[48:51], v[120:123]
v_mfma_f32_16x16x32_bf16 v[124:127], a[80:83], a[52:55], v[124:127]
ds_read_b64_tr_b16 a[40:41], v54 offset:0
s_add_u32 m0, s69, 65536
v_mfma_f32_16x16x32_bf16 v[128:131], a[80:83], a[56:59], v[128:131]
ds_read_b64_tr_b16 a[42:43], v54 offset:2048
v_mfma_f32_16x16x32_bf16 v[132:135], a[80:83], a[60:63], v[132:135]
ds_read_b64_tr_b16 a[44:45], v55 offset:0
v_mfma_f32_16x16x32_bf16 v[136:139], a[84:87], a[48:51], v[136:139]
buffer_load_dwordx4 v33, s[24:27], s11 offen offset:0 lds
ds_read_b64_tr_b16 a[46:47], v55 offset:2048
v_mfma_f32_16x16x32_bf16 v[140:143], a[84:87], a[52:55], v[140:143]
v_mfma_f32_16x16x32_bf16 v[144:147], a[84:87], a[56:59], v[144:147]
v_mfma_f32_16x16x32_bf16 v[148:151], a[84:87], a[60:63], v[148:151]
buffer_load_dwordx4 v34, s[24:27], s11 offen offset:1024 lds
v_mfma_f32_16x16x32_bf16 v[152:155], a[88:91], a[48:51], v[152:155]
v_mfma_f32_16x16x32_bf16 v[156:159], a[88:91], a[52:55], v[156:159]
v_mfma_f32_16x16x32_bf16 v[160:163], a[88:91], a[56:59], v[160:163]
v_mfma_f32_16x16x32_bf16 v[164:167], a[88:91], a[60:63], v[164:167]
s_waitcnt vmcnt(14) lgkmcnt(0)
s_barrier
v_mfma_f32_16x16x32_bf16 v[56:59], a[20:23], a[4:7], v[56:59]
ds_read_b128 a[48:51], v46 offset:16384
s_add_u32 m0, s69, 65536
v_mfma_f32_16x16x32_bf16 v[60:63], a[20:23], a[8:11], v[60:63]
ds_read_b128 a[52:55], v46 offset:18432
v_mfma_f32_16x16x32_bf16 v[64:67], a[20:23], a[12:15], v[64:67]
ds_read_b128 a[56:59], v48 offset:16384
v_mfma_f32_16x16x32_bf16 v[68:71], a[20:23], a[16:19], v[68:71]
ds_read_b128 a[60:63], v48 offset:18432
buffer_load_dwordx4 v[168:171], v214, s[32:35], 0 offen offset:0 sc1
v_mfma_f32_16x16x32_bf16 v[72:75], a[24:27], a[4:7], v[72:75]
buffer_load_dwordx4 v35, s[24:27], s11 offen offset:2048 lds
ds_read_b64_tr_b16 a[64:65], v49 offset:16384
v_mfma_f32_16x16x32_bf16 v[76:79], a[24:27], a[8:11], v[76:79]
ds_read_b64_tr_b16 a[66:67], v49 offset:18432
v_mfma_f32_16x16x32_bf16 v[80:83], a[24:27], a[12:15], v[80:83]
v_mfma_f32_16x16x32_bf16 v[84:87], a[24:27], a[16:19], v[84:87]
ds_read_b64_tr_b16 a[68:69], v50 offset:16384
buffer_load_dwordx4 v36, s[24:27], s11 offen offset:3072 lds
v_mfma_f32_16x16x32_bf16 v[88:91], a[28:31], a[4:7], v[88:91]
ds_read_b64_tr_b16 a[70:71], v50 offset:18432
v_mfma_f32_16x16x32_bf16 v[92:95], a[28:31], a[8:11], v[92:95]
ds_read_b64_tr_b16 a[72:73], v51 offset:16384
v_mfma_f32_16x16x32_bf16 v[96:99], a[28:31], a[12:15], v[96:99]
s_add_u32 m0, s69, 0
ds_read_b64_tr_b16 a[74:75], v51 offset:18432
v_mfma_f32_16x16x32_bf16 v[100:103], a[28:31], a[16:19], v[100:103]
buffer_load_dwordx4 v[172:175], v214, s[32:35], 0 offen offset:512 sc1
v_mfma_f32_16x16x32_bf16 v[104:107], a[32:35], a[4:7], v[104:107]
ds_read_b64_tr_b16 a[76:77], v52 offset:16384
v_mfma_f32_16x16x32_bf16 v[108:111], a[32:35], a[8:11], v[108:111]
ds_read_b64_tr_b16 a[78:79], v52 offset:18432
buffer_load_dwordx4 v37, s[28:31], s19 offen offset:0 lds
v_mfma_f32_16x16x32_bf16 v[112:115], a[32:35], a[12:15], v[112:115]
ds_read_b64_tr_b16 a[80:81], v53 offset:16384
v_mfma_f32_16x16x32_bf16 v[116:119], a[32:35], a[16:19], v[116:119]
ds_read_b64_tr_b16 a[82:83], v53 offset:18432
v_mfma_f32_16x16x32_bf16 v[120:123], a[36:39], a[4:7], v[120:123]
v_mfma_f32_16x16x32_bf16 v[124:127], a[36:39], a[8:11], v[124:127]
ds_read_b64_tr_b16 a[84:85], v54 offset:16384
buffer_load_dwordx4 v38, s[28:31], s19 offen offset:1024 lds
v_mfma_f32_16x16x32_bf16 v[128:131], a[36:39], a[12:15], v[128:131]
buffer_load_dwordx4 v[176:179], v214, s[32:35], 0 offen offset:1024 sc1
ds_read_b64_tr_b16 a[86:87], v54 offset:18432
v_mfma_f32_16x16x32_bf16 v[132:135], a[36:39], a[16:19], v[132:135]
ds_read_b64_tr_b16 a[88:89], v55 offset:16384
v_mfma_f32_16x16x32_bf16 v[136:139], a[40:43], a[4:7], v[136:139]
buffer_load_dwordx4 v39, s[28:31], s19 offen offset:2048 lds
ds_read_b64_tr_b16 a[90:91], v55 offset:18432
v_mfma_f32_16x16x32_bf16 v[140:143], a[40:43], a[8:11], v[140:143]
v_mfma_f32_16x16x32_bf16 v[144:147], a[40:43], a[12:15], v[144:147]
v_mfma_f32_16x16x32_bf16 v[148:151], a[40:43], a[16:19], v[148:151]
buffer_load_dwordx4 v40, s[28:31], s19 offen offset:3072 lds
v_mfma_f32_16x16x32_bf16 v[152:155], a[44:47], a[4:7], v[152:155]
v_mfma_f32_16x16x32_bf16 v[156:159], a[44:47], a[8:11], v[156:159]
v_mfma_f32_16x16x32_bf16 v[160:163], a[44:47], a[12:15], v[160:163]
v_mfma_f32_16x16x32_bf16 v[164:167], a[44:47], a[16:19], v[164:167]
s_waitcnt vmcnt(15) lgkmcnt(0)
s_barrier
v_mfma_f32_16x16x32_bf16 v[56:59], a[64:67], a[48:51], v[56:59]
ds_read_b128 a[4:7], v45 offset:32768
v_mfma_f32_16x16x32_bf16 v[60:63], a[64:67], a[52:55], v[60:63]
ds_read_b128 a[8:11], v45 offset:34816
s_add_u32 m0, s69, 16384
v_mfma_f32_16x16x32_bf16 v[64:67], a[64:67], a[56:59], v[64:67]
ds_read_b128 a[12:15], v47 offset:32768
v_mfma_f32_16x16x32_bf16 v[68:71], a[64:67], a[60:63], v[68:71]
buffer_load_dwordx4 v[180:183], v214, s[32:35], 0 offen offset:1536 sc1
ds_read_b128 a[16:19], v47 offset:34816
v_mfma_f32_16x16x32_bf16 v[72:75], a[68:71], a[48:51], v[72:75]
ds_read_b64_tr_b16 a[20:21], v49 offset:32768
v_mfma_f32_16x16x32_bf16 v[76:79], a[68:71], a[52:55], v[76:79]
ds_read_b64_tr_b16 a[22:23], v49 offset:34816
v_mfma_f32_16x16x32_bf16 v[80:83], a[68:71], a[56:59], v[80:83]
buffer_load_dwordx4 v41, s[28:31], s19 offen offset:0 lds
v_mfma_f32_16x16x32_bf16 v[84:87], a[68:71], a[60:63], v[84:87]
ds_read_b64_tr_b16 a[24:25], v50 offset:32768
v_mfma_f32_16x16x32_bf16 v[88:91], a[72:75], a[48:51], v[88:91]
buffer_load_dwordx4 v[184:187], v214, s[32:35], 0 offen offset:2048 sc1
ds_read_b64_tr_b16 a[26:27], v50 offset:34816
v_mfma_f32_16x16x32_bf16 v[92:95], a[72:75], a[52:55], v[92:95]
ds_read_b64_tr_b16 a[28:29], v51 offset:32768
v_mfma_f32_16x16x32_bf16 v[96:99], a[72:75], a[56:59], v[96:99]
ds_read_b64_tr_b16 a[30:31], v51 offset:34816
v_mfma_f32_16x16x32_bf16 v[100:103], a[72:75], a[60:63], v[100:103]
v_mfma_f32_16x16x32_bf16 v[104:107], a[76:79], a[48:51], v[104:107]
ds_read_b64_tr_b16 a[32:33], v52 offset:32768
buffer_load_dwordx4 v42, s[28:31], s19 offen offset:1024 lds
v_mfma_f32_16x16x32_bf16 v[108:111], a[76:79], a[52:55], v[108:111]
ds_read_b64_tr_b16 a[34:35], v52 offset:34816
buffer_load_dwordx4 v[188:191], v214, s[32:35], 0 offen offset:2560 sc1
v_mfma_f32_16x16x32_bf16 v[112:115], a[76:79], a[56:59], v[112:115]
ds_read_b64_tr_b16 a[36:37], v53 offset:32768
v_mfma_f32_16x16x32_bf16 v[116:119], a[76:79], a[60:63], v[116:119]
ds_read_b64_tr_b16 a[38:39], v53 offset:34816
v_mfma_f32_16x16x32_bf16 v[120:123], a[80:83], a[48:51], v[120:123]
v_mfma_f32_16x16x32_bf16 v[124:127], a[80:83], a[52:55], v[124:127]
ds_read_b64_tr_b16 a[40:41], v54 offset:32768
buffer_load_dwordx4 v43, s[28:31], s19 offen offset:2048 lds
v_mfma_f32_16x16x32_bf16 v[128:131], a[80:83], a[56:59], v[128:131]
ds_read_b64_tr_b16 a[42:43], v54 offset:34816
buffer_load_dwordx4 v[192:195], v214, s[32:35], 0 offen offset:3072 sc1
v_mfma_f32_16x16x32_bf16 v[132:135], a[80:83], a[60:63], v[132:135]
ds_read_b64_tr_b16 a[44:45], v55 offset:32768
v_mfma_f32_16x16x32_bf16 v[136:139], a[84:87], a[48:51], v[136:139]
ds_read_b64_tr_b16 a[46:47], v55 offset:34816
v_mfma_f32_16x16x32_bf16 v[140:143], a[84:87], a[52:55], v[140:143]
v_mfma_f32_16x16x32_bf16 v[144:147], a[84:87], a[56:59], v[144:147]
buffer_load_dwordx4 v44, s[28:31], s19 offen offset:3072 lds
v_mfma_f32_16x16x32_bf16 v[148:151], a[84:87], a[60:63], v[148:151]
v_mfma_f32_16x16x32_bf16 v[152:155], a[88:91], a[48:51], v[152:155]
v_mfma_f32_16x16x32_bf16 v[156:159], a[88:91], a[52:55], v[156:159]
v_mfma_f32_16x16x32_bf16 v[160:163], a[88:91], a[56:59], v[160:163]
v_mfma_f32_16x16x32_bf16 v[164:167], a[88:91], a[60:63], v[164:167]
s_waitcnt vmcnt(19) lgkmcnt(0)
s_barrier
v_mfma_f32_16x16x32_bf16 v[56:59], a[20:23], a[4:7], v[56:59]
ds_read_b128 a[48:51], v46 offset:32768
s_add_u32 m0, s85, 114688
v_mfma_f32_16x16x32_bf16 v[60:63], a[20:23], a[8:11], v[60:63]
ds_read_b128 a[52:55], v46 offset:34816
v_mfma_f32_16x16x32_bf16 v[64:67], a[20:23], a[12:15], v[64:67]
buffer_load_dwordx4 v12, s[36:39], s76 offen offset:0 lds
ds_read_b128 a[56:59], v48 offset:32768
v_mfma_f32_16x16x32_bf16 v[68:71], a[20:23], a[16:19], v[68:71]
ds_read_b128 a[60:63], v48 offset:34816
v_mfma_f32_16x16x32_bf16 v[72:75], a[24:27], a[4:7], v[72:75]
buffer_load_dwordx4 v13, s[36:39], s76 offen offset:1024 lds
ds_read_b64_tr_b16 a[64:65], v49 offset:49152
v_mfma_f32_16x16x32_bf16 v[76:79], a[24:27], a[8:11], v[76:79]
ds_read_b64_tr_b16 a[66:67], v49 offset:51200
v_mfma_f32_16x16x32_bf16 v[80:83], a[24:27], a[12:15], v[80:83]
s_add_u32 s76, s76, 14336
v_mfma_f32_16x16x32_bf16 v[84:87], a[24:27], a[16:19], v[84:87]
ds_read_b64_tr_b16 a[68:69], v50 offset:49152
v_mfma_f32_16x16x32_bf16 v[88:91], a[28:31], a[4:7], v[88:91]
s_add_u32 m0, s85, 122880
ds_read_b64_tr_b16 a[70:71], v50 offset:51200
v_mfma_f32_16x16x32_bf16 v[92:95], a[28:31], a[8:11], v[92:95]
ds_read_b64_tr_b16 a[72:73], v51 offset:49152
v_mfma_f32_16x16x32_bf16 v[96:99], a[28:31], a[12:15], v[96:99]
buffer_load_dwordx4 v12, s[36:39], s76 offen offset:0 lds
ds_read_b64_tr_b16 a[74:75], v51 offset:51200
v_mfma_f32_16x16x32_bf16 v[100:103], a[28:31], a[16:19], v[100:103]
v_mfma_f32_16x16x32_bf16 v[104:107], a[32:35], a[4:7], v[104:107]
ds_read_b64_tr_b16 a[76:77], v52 offset:49152
buffer_load_dwordx4 v13, s[36:39], s76 offen offset:1024 lds
v_mfma_f32_16x16x32_bf16 v[108:111], a[32:35], a[8:11], v[108:111]
ds_read_b64_tr_b16 a[78:79], v52 offset:51200
v_mfma_f32_16x16x32_bf16 v[112:115], a[32:35], a[12:15], v[112:115]
s_add_u32 s76, s76, 14336
ds_read_b64_tr_b16 a[80:81], v53 offset:49152
v_mfma_f32_16x16x32_bf16 v[116:119], a[32:35], a[16:19], v[116:119]
ds_read_b64_tr_b16 a[82:83], v53 offset:51200
v_mfma_f32_16x16x32_bf16 v[120:123], a[36:39], a[4:7], v[120:123]
s_cmp_eq_u32 s76, s79
s_cselect_b32 s76, s78, s76
v_mfma_f32_16x16x32_bf16 v[124:127], a[36:39], a[8:11], v[124:127]
ds_read_b64_tr_b16 a[84:85], v54 offset:49152
v_mfma_f32_16x16x32_bf16 v[128:131], a[36:39], a[12:15], v[128:131]
ds_read_b64_tr_b16 a[86:87], v54 offset:51200
s_add_u32 m0, s85, 131072
v_mfma_f32_16x16x32_bf16 v[132:135], a[36:39], a[16:19], v[132:135]
ds_read_b64_tr_b16 a[88:89], v55 offset:49152
v_mfma_f32_16x16x32_bf16 v[136:139], a[40:43], a[4:7], v[136:139]
buffer_load_dwordx4 v12, s[36:39], s76 offen offset:0 lds
ds_read_b64_tr_b16 a[90:91], v55 offset:51200
v_mfma_f32_16x16x32_bf16 v[140:143], a[40:43], a[8:11], v[140:143]
v_mfma_f32_16x16x32_bf16 v[144:147], a[40:43], a[12:15], v[144:147]
buffer_load_dwordx4 v13, s[36:39], s76 offen offset:1024 lds
v_mfma_f32_16x16x32_bf16 v[148:151], a[40:43], a[16:19], v[148:151]
v_mfma_f32_16x16x32_bf16 v[152:155], a[44:47], a[4:7], v[152:155]
s_add_u32 s76, s76, 14336
v_mfma_f32_16x16x32_bf16 v[156:159], a[44:47], a[8:11], v[156:159]
v_mfma_f32_16x16x32_bf16 v[160:163], a[44:47], a[12:15], v[160:163]
v_mfma_f32_16x16x32_bf16 v[164:167], a[44:47], a[16:19], v[164:167]
s_waitcnt vmcnt(14) lgkmcnt(0)
s_barrier
v_mfma_f32_16x16x32_bf16 v[56:59], a[64:67], a[48:51], v[56:59]
ds_read_b128 a[4:7], v45 offset:0
s_add_u32 m0, s85, 139264
v_mfma_f32_16x16x32_bf16 v[60:63], a[64:67], a[52:55], v[60:63]
ds_read_b128 a[8:11], v45 offset:2048
v_mfma_f32_16x16x32_bf16 v[64:67], a[64:67], a[56:59], v[64:67]
ds_read_b128 a[12:15], v47 offset:0
v_mfma_f32_16x16x32_bf16 v[68:71], a[64:67], a[60:63], v[68:71]
ds_read_b128 a[16:19], v47 offset:2048
buffer_load_dwordx4 v12, s[36:39], s76 offen offset:0 lds
v_mfma_f32_16x16x32_bf16 v[72:75], a[68:71], a[48:51], v[72:75]
ds_read_b64_tr_b16 a[20:21], v49 offset:0
v_mfma_f32_16x16x32_bf16 v[76:79], a[68:71], a[52:55], v[76:79]
ds_read_b64_tr_b16 a[22:23], v49 offset:2048
v_mfma_f32_16x16x32_bf16 v[80:83], a[68:71], a[56:59], v[80:83]
buffer_load_dwordx4 v13, s[36:39], s76 offen offset:1024 lds
v_mfma_f32_16x16x32_bf16 v[84:87], a[68:71], a[60:63], v[84:87]
ds_read_b64_tr_b16 a[24:25], v50 offset:0
s_lshl_b32 s66, s83, 12
v_mfma_f32_16x16x32_bf16 v[88:91], a[72:75], a[48:51], v[88:91]
ds_read_b64_tr_b16 a[26:27], v50 offset:2048
s_add_u32 s6, s66, 4096
v_mfma_f32_16x16x32_bf16 v[92:95], a[72:75], a[52:55], v[92:95]
s_add_u32 s76, s76, 14336
s_cmp_eq_u32 s6, 28672
s_cselect_b32 s6, 0, s6
v_mfma_f32_16x16x32_bf16 v[96:99], a[72:75], a[56:59], v[96:99]
ds_read_b64_tr_b16 a[28:29], v51 offset:0
s_add_u32 s7, s6, 4096
v_mfma_f32_16x16x32_bf16 v[100:103], a[72:75], a[60:63], v[100:103]
ds_read_b64_tr_b16 a[30:31], v51 offset:2048
v_mfma_f32_16x16x32_bf16 v[104:107], a[76:79], a[48:51], v[104:107]
s_cmp_eq_u32 s7, 28672
s_cselect_b32 s7, 0, s7
s_add_u32 s8, s7, 4096
v_mfma_f32_16x16x32_bf16 v[108:111], a[76:79], a[52:55], v[108:111]
ds_read_b64_tr_b16 a[32:33], v52 offset:0
v_mfma_f32_16x16x32_bf16 v[112:115], a[76:79], a[56:59], v[112:115]
ds_read_b64_tr_b16 a[34:35], v52 offset:2048
v_mfma_f32_16x16x32_bf16 v[116:119], a[76:79], a[60:63], v[116:119]
ds_read_b64_tr_b16 a[36:37], v53 offset:0
v_mfma_f32_16x16x32_bf16 v[120:123], a[80:83], a[48:51], v[120:123]
ds_read_b64_tr_b16 a[38:39], v53 offset:2048
v_mfma_f32_16x16x32_bf16 v[124:127], a[80:83], a[52:55], v[124:127]
s_cmp_eq_u32 s76, s79
s_cselect_b32 s76, s78, s76
s_add_u32 m0, s85, 147456
s_cmp_eq_u32 s8, 28672
s_cselect_b32 s8, 0, s8
v_mfma_f32_16x16x32_bf16 v[128:131], a[80:83], a[56:59], v[128:131]
ds_read_b64_tr_b16 a[40:41], v54 offset:0
s_add_u32 s9, s8, 4096
v_mfma_f32_16x16x32_bf16 v[132:135], a[80:83], a[60:63], v[132:135]
buffer_load_dwordx4 v12, s[36:39], s76 offen offset:0 lds
ds_read_b64_tr_b16 a[42:43], v54 offset:2048
s_cmp_eq_u32 s9, 28672
s_cselect_b32 s9, 0, s9
v_mfma_f32_16x16x32_bf16 v[136:139], a[84:87], a[48:51], v[136:139]
ds_read_b64_tr_b16 a[44:45], v55 offset:0
s_add_u32 s10, s9, 4096
v_mfma_f32_16x16x32_bf16 v[140:143], a[84:87], a[52:55], v[140:143]
ds_read_b64_tr_b16 a[46:47], v55 offset:2048
buffer_load_dwordx4 v13, s[36:39], s76 offen offset:1024 lds
s_cmp_eq_u32 s10, 28672
s_cselect_b32 s10, 0, s10
v_mfma_f32_16x16x32_bf16 v[144:147], a[84:87], a[56:59], v[144:147]
s_add_u32 s11, s10, 4096
s_cmp_eq_u32 s11, 28672
s_cselect_b32 s11, 0, s11
v_mfma_f32_16x16x32_bf16 v[148:151], a[84:87], a[60:63], v[148:151]
s_lshl_b32 s12, s82, 12
s_add_u32 s13, s12, 4096
s_and_b32 s13, s13, 0x3fff
v_mfma_f32_16x16x32_bf16 v[152:155], a[88:91], a[48:51], v[152:155]
s_add_u32 s14, s13, 4096
s_and_b32 s14, s14, 0x3fff
s_add_u32 s15, s14, 4096
v_mfma_f32_16x16x32_bf16 v[156:159], a[88:91], a[52:55], v[156:159]
s_and_b32 s15, s15, 0x3fff
s_add_u32 s76, s76, 14336
v_mfma_f32_16x16x32_bf16 v[160:163], a[88:91], a[56:59], v[160:163]
v_mfma_f32_16x16x32_bf16 v[164:167], a[88:91], a[60:63], v[164:167]
s_waitcnt vmcnt(10) lgkmcnt(0)
s_barrier
v_mfma_f32_16x16x32_bf16 v[56:59], a[20:23], a[4:7], v[56:59]
ds_read_b128 a[48:51], v46 offset:0
s_waitcnt vmcnt(11)
v_mfma_f32_16x16x32_bf16 v[60:63], a[20:23], a[8:11], v[60:63]
ds_read_b128 a[52:55], v46 offset:2048
v_xor_b32 v196, s86, v169
v_mfma_f32_16x16x32_bf16 v[64:67], a[20:23], a[12:15], v[64:67]
v_bitop3_b32 v196, v171, s86, v196 bitop3:0xbe
v_bitop3_b32 v196, v173, s86, v196 bitop3:0xbe
v_mfma_f32_16x16x32_bf16 v[68:71], a[20:23], a[16:19], v[68:71]
ds_read_b128 a[56:59], v48 offset:0
v_bitop3_b32 v196, v175, s86, v196 bitop3:0xbe
v_mfma_f32_16x16x32_bf16 v[72:75], a[24:27], a[4:7], v[72:75]
ds_read_b128 a[60:63], v48 offset:2048
v_bitop3_b32 v196, v177, s86, v196 bitop3:0xbe
v_mfma_f32_16x16x32_bf16 v[76:79], a[24:27], a[8:11], v[76:79]
ds_read_b64_tr_b16 a[64:65], v49 offset:16384
v_bitop3_b32 v196, v179, s86, v196 bitop3:0xbe
v_mfma_f32_16x16x32_bf16 v[80:83], a[24:27], a[12:15], v[80:83]
ds_read_b64_tr_b16 a[66:67], v49 offset:18432
v_bitop3_b32 v196, v181, s86, v196 bitop3:0xbe
v_mfma_f32_16x16x32_bf16 v[84:87], a[24:27], a[16:19], v[84:87]
v_bitop3_b32 v196, v183, s86, v196 bitop3:0xbe
v_bitop3_b32 v196, v185, s86, v196 bitop3:0xbe
v_mfma_f32_16x16x32_bf16 v[88:91], a[28:31], a[4:7], v[88:91]
ds_read_b64_tr_b16 a[68:69], v50 offset:16384
v_bitop3_b32 v196, v187, s86, v196 bitop3:0xbe
v_mfma_f32_16x16x32_bf16 v[92:95], a[28:31], a[8:11], v[92:95]
ds_read_b64_tr_b16 a[70:71], v50 offset:18432
v_bitop3_b32 v196, v189, s86, v196 bitop3:0xbe
PADF2:
s_cbranch_execz BACK_F
v_mfma_f32_16x16x32_bf16 v[96:99], a[28:31], a[12:15], v[96:99]
ds_read_b64_tr_b16 a[72:73], v51 offset:16384
v_bitop3_b32 v196, v191, s86, v196 bitop3:0xbe
v_mfma_f32_16x16x32_bf16 v[100:103], a[28:31], a[16:19], v[100:103]
ds_read_b64_tr_b16 a[74:75], v51 offset:18432
v_bitop3_b32 v196, v193, s86, v196 bitop3:0xbe
v_mfma_f32_16x16x32_bf16 v[104:107], a[32:35], a[4:7], v[104:107]
v_bitop3_b32 v196, v195, s86, v196 bitop3:0xbe
v_cmp_ne_u32 vcc, 0, v196
v_mfma_f32_16x16x32_bf16 v[108:111], a[32:35], a[8:11], v[108:111]
ds_read_b64_tr_b16 a[76:77], v52 offset:16384
v_mfma_f32_16x16x32_bf16 v[112:115], a[32:35], a[12:15], v[112:115]
ds_read_b64_tr_b16 a[78:79], v52 offset:18432
v_mfma_f32_16x16x32_bf16 v[116:119], a[32:35], a[16:19], v[116:119]
ds_read_b64_tr_b16 a[80:81], v53 offset:16384
v_mfma_f32_16x16x32_bf16 v[120:123], a[36:39], a[4:7], v[120:123]
ds_read_b64_tr_b16 a[82:83], v53 offset:18432
s_cmp_lg_u64 vcc, 0
s_cbranch_scc1 GA_S
GA_X:
v_add_f32 v168, v168, v172
v_mfma_f32_16x16x32_bf16 v[124:127], a[36:39], a[8:11], v[124:127]
v_add_f32 v176, v176, v180
v_add_f32 v184, v184, v188
v_mfma_f32_16x16x32_bf16 v[128:131], a[36:39], a[12:15], v[128:131]
ds_read_b64_tr_b16 a[84:85], v54 offset:16384
v_add_f32 v168, v168, v176
v_mfma_f32_16x16x32_bf16 v[132:135], a[36:39], a[16:19], v[132:135]
ds_read_b64_tr_b16 a[86:87], v54 offset:18432
v_add_f32 v184, v184, v192
v_mfma_f32_16x16x32_bf16 v[136:139], a[40:43], a[4:7], v[136:139]
ds_read_b64_tr_b16 a[88:89], v55 offset:16384
v_add_f32 v168, v168, v184
v_add_f32 v170, v170, v174
v_mfma_f32_16x16x32_bf16 v[140:143], a[40:43], a[8:11], v[140:143]
ds_read_b64_tr_b16 a[90:91], v55 offset:18432
v_add_f32 v178, v178, v182
v_mfma_f32_16x16x32_bf16 v[144:147], a[40:43], a[12:15], v[144:147]
v_add_f32 v186, v186, v190
v_add_f32 v170, v170, v178
v_mfma_f32_16x16x32_bf16 v[148:151], a[40:43], a[16:19], v[148:151]
v_add_f32 v186, v186, v194
v_add_f32 v170, v170, v186
v_mfma_f32_16x16x32_bf16 v[152:155], a[44:47], a[4:7], v[152:155]
v_mul_f32 v168, v215, v168
v_mul_f32 v169, v215, v170
v_mfma_f32_16x16x32_bf16 v[156:159], a[44:47], a[8:11], v[156:159]
ds_write_b64 v216, v[168:169] offset:24576
v_mfma_f32_16x16x32_bf16 v[160:163], a[44:47], a[12:15], v[160:163]
v_mfma_f32_16x16x32_bf16 v[164:167], a[44:47], a[16:19], v[164:167]
s_waitcnt lgkmcnt(0)
s_barrier
v_mfma_f32_16x16x32_bf16 v[56:59], a[64:67], a[48:51], v[56:59]
s_add_u32 m0, s85, 81920
v_mfma_f32_16x16x32_bf16 v[60:63], a[64:67], a[52:55], v[60:63]
buffer_load_dwordx4 v12, s[36:39], s76 offen offset:0 lds
ds_read_b32 v218, v206 offset:24576
v_mfma_f32_16x16x32_bf16 v[64:67], a[64:67], a[56:59], v[64:67]
buffer_load_dwordx4 v13, s[36:39], s76 offen offset:1024 lds
v_mfma_f32_16x16x32_bf16 v[68:71], a[64:67], a[60:63], v[68:71]
ds_read_b32 v219, v206 offset:24640
v_mfma_f32_16x16x32_bf16 v[72:75], a[68:71], a[48:51], v[72:75]
s_add_u32 s76, s76, 14336
v_mfma_f32_16x16x32_bf16 v[76:79], a[68:71], a[52:55], v[76:79]
ds_read_b32 v220, v207 offset:24576
v_mfma_f32_16x16x32_bf16 v[80:83], a[68:71], a[56:59], v[80:83]
s_cmp_eq_u32 s76, s79
s_cselect_b32 s76, s78, s76
v_mfma_f32_16x16x32_bf16 v[84:87], a[68:71], a[60:63], v[84:87]
ds_read_b32 v221, v207 offset:24640
s_add_u32 m0, s85, 90112
v_mfma_f32_16x16x32_bf16 v[88:91], a[72:75], a[48:51], v[88:91]
buffer_load_dwordx4 v12, s[36:39], s76 offen offset:0 lds
ds_read_b128 v[168:171], v208 offset:25600
v_mfma_f32_16x16x32_bf16 v[92:95], a[72:75], a[52:55], v[92:95]
v_mfma_f32_16x16x32_bf16 v[96:99], a[72:75], a[56:59], v[96:99]
buffer_load_dwordx4 v13, s[36:39], s76 offen offset:1024 lds
ds_read_b128 v[172:175], v208 offset:25664
v_mfma_f32_16x16x32_bf16 v[100:103], a[72:75], a[60:63], v[100:103]
s_add_u32 s76, s76, 14336
v_mfma_f32_16x16x32_bf16 v[104:107], a[76:79], a[48:51], v[104:107]
ds_read_b128 v[176:179], v208 offset:25728
v_mfma_f32_16x16x32_bf16 v[108:111], a[76:79], a[52:55], v[108:111]
s_add_u32 m0, s85, 32768
v_mfma_f32_16x16x32_bf16 v[112:115], a[76:79], a[56:59], v[112:115]
buffer_load_dwordx4 v12, s[36:39], s76 offen offset:0 lds
ds_read_b128 v[180:183], v208 offset:25792
v_mfma_f32_16x16x32_bf16 v[116:119], a[76:79], a[60:63], v[116:119]
buffer_load_dwordx4 v13, s[36:39], s76 offen offset:1024 lds
v_mfma_f32_16x16x32_bf16 v[120:123], a[80:83], a[48:51], v[120:123]
ds_read_b128 v[184:187], v209 offset:25600
v_mfma_f32_16x16x32_bf16 v[124:127], a[80:83], a[52:55], v[124:127]
s_add_u32 s76, s76, 14336
v_mfma_f32_16x16x32_bf16 v[128:131], a[80:83], a[56:59], v[128:131]
ds_read_b128 v[188:191], v209 offset:25664
v_mfma_f32_16x16x32_bf16 v[132:135], a[80:83], a[60:63], v[132:135]
s_cmp_eq_u32 s76, s79
s_cselect_b32 s76, s78, s76
v_mfma_f32_16x16x32_bf16 v[136:139], a[84:87], a[48:51], v[136:139]
s_add_u32 m0, s85, 40960
ds_read_b128 v[192:195], v209 offset:25728
v_mfma_f32_16x16x32_bf16 v[140:143], a[84:87], a[52:55], v[140:143]
buffer_load_dwordx4 v12, s[36:39], s76 offen offset:0 lds
v_mfma_f32_16x16x32_bf16 v[144:147], a[84:87], a[56:59], v[144:147]
v_mfma_f32_16x16x32_bf16 v[148:151], a[84:87], a[60:63], v[148:151]
buffer_load_dwordx4 v13, s[36:39], s76 offen offset:1024 lds
v_mfma_f32_16x16x32_bf16 v[152:155], a[88:91], a[48:51], v[152:155]
s_add_u32 s76, s76, 14336
v_mfma_f32_16x16x32_bf16 v[156:159], a[88:91], a[52:55], v[156:159]
v_mfma_f32_16x16x32_bf16 v[160:163], a[88:91], a[56:59], v[160:163]
v_mfma_f32_16x16x32_bf16 v[164:167], a[88:91], a[60:63], v[164:167]
s_waitcnt lgkmcnt(0)
v_pk_fma_f32 v[56:57], v[168:169], v[218:219], v[56:57] op_sel_hi:[1,0,1]
v_pk_fma_f32 v[58:59], v[170:171], v[218:219], v[58:59] op_sel_hi:[1,0,1]
v_pk_fma_f32 v[60:61], v[168:169], v[218:219], v[60:61] op_sel:[0,1,0] op_sel_hi:[1,1,1]
v_pk_fma_f32 v[62:63], v[170:171], v[218:219], v[62:63] op_sel:[0,1,0] op_sel_hi:[1,1,1]
v_cvt_pk_bf16_f32 v224, v56, v57
v_cvt_pk_bf16_f32 v225, v58, v59
v_cvt_pk_bf16_f32 v226, v60, v61
v_cvt_pk_bf16_f32 v227, v62, v63
v_pk_max_i16 v224, v224, 0
v_pk_max_i16 v225, v225, 0
v_pk_max_i16 v226, v226, 0
v_pk_max_i16 v227, v227, 0
v_pk_fma_f32 v[64:65], v[168:169], v[220:221], v[64:65] op_sel_hi:[1,0,1]
v_pk_fma_f32 v[66:67], v[170:171], v[220:221], v[66:67] op_sel_hi:[1,0,1]
v_pk_fma_f32 v[68:69], v[168:169], v[220:221], v[68:69] op_sel:[0,1,0] op_sel_hi:[1,1,1]
v_pk_fma_f32 v[70:71], v[170:171], v[220:221], v[70:71] op_sel:[0,1,0] op_sel_hi:[1,1,1]
s_add_u32 s63, s70, 0
v_permlane16_swap_b32 v224, v226
v_permlane16_swap_b32 v225, v227
buffer_store_dwordx4 v[224:227], v210, s[32:35], s63 offen sc1
s_nop 0
v_cvt_pk_bf16_f32 v228, v64, v65
v_cvt_pk_bf16_f32 v229, v66, v67
v_cvt_pk_bf16_f32 v230, v68, v69
v_cvt_pk_bf16_f32 v231, v70, v71
v_pk_max_i16 v228, v228, 0
v_pk_max_i16 v229, v229, 0
v_pk_max_i16 v230, v230, 0
v_pk_max_i16 v231, v231, 0
v_pk_fma_f32 v[72:73], v[172:173], v[218:219], v[72:73] op_sel_hi:[1,0,1]
v_pk_fma_f32 v[74:75], v[174:175], v[218:219], v[74:75] op_sel_hi:[1,0,1]
v_pk_fma_f32 v[76:77], v[172:173], v[218:219], v[76:77] op_sel:[0,1,0] op_sel_hi:[1,1,1]
v_pk_fma_f32 v[78:79], v[174:175], v[218:219], v[78:79] op_sel:[0,1,0] op_sel_hi:[1,1,1]
s_add_u32 s63, s70, 0
v_permlane16_swap_b32 v228, v230
v_permlane16_swap_b32 v229, v231
buffer_store_dwordx4 v[228:231], v211, s[32:35], s63 offen sc1
s_nop 0
v_cvt_pk_bf16_f32 v232, v72, v73
v_cvt_pk_bf16_f32 v233, v74, v75
v_cvt_pk_bf16_f32 v234, v76, v77
v_cvt_pk_bf16_f32 v235, v78, v79
v_pk_max_i16 v232, v232, 0
v_pk_max_i16 v233, v233, 0
v_pk_max_i16 v234, v234, 0
v_pk_max_i16 v235, v235, 0
v_pk_fma_f32 v[80:81], v[172:173], v[220:221], v[80:81] op_sel_hi:[1,0,1]
v_pk_fma_f32 v[82:83], v[174:175], v[220:221], v[82:83] op_sel_hi:[1,0,1]
v_pk_fma_f32 v[84:85], v[172:173], v[220:221], v[84:85] op_sel:[0,1,0] op_sel_hi:[1,1,1]
v_pk_fma_f32 v[86:87], v[174:175], v[220:221], v[86:87] op_sel:[0,1,0] op_sel_hi:[1,1,1]
s_add_u32 s63, s70, 2048
v_permlane16_swap_b32 v232, v234
v_permlane16_swap_b32 v233, v235
buffer_store_dwordx4 v[232:235], v210, s[32:35], s63 offen sc1
v_cvt_pk_bf16_f32 v236, v80, v81
v_cvt_pk_bf16_f32 v237, v82, v83
v_cvt_pk_bf16_f32 v238, v84, v85
v_cvt_pk_bf16_f32 v239, v86, v87
v_pk_max_i16 v236, v236, 0
v_pk_max_i16 v237, v237, 0
v_pk_max_i16 v238, v238, 0
v_pk_max_i16 v239, v239, 0
s_waitcnt lgkmcnt(0)
v_pk_fma_f32 v[88:89], v[176:177], v[218:219], v[88:89] op_sel_hi:[1,0,1]
v_pk_fma_f32 v[90:91], v[178:179], v[218:219], v[90:91] op_sel_hi:[1,0,1]
v_pk_fma_f32 v[92:93], v[176:177], v[218:219], v[92:93] op_sel:[0,1,0] op_sel_hi:[1,1,1]
v_pk_fma_f32 v[94:95], v[178:179], v[218:219], v[94:95] op_sel:[0,1,0] op_sel_hi:[1,1,1]
s_add_u32 s63, s70, 2048
v_permlane16_swap_b32 v236, v238
v_permlane16_swap_b32 v237, v239
buffer_store_dwordx4 v[236:239], v211, s[32:35], s63 offen sc1
s_nop 0
v_cvt_pk_bf16_f32 v224, v88, v89
v_cvt_pk_bf16_f32 v225, v90, v91
v_cvt_pk_bf16_f32 v226, v92, v93
v_cvt_pk_bf16_f32 v227, v94, v95
v_pk_max_i16 v224, v224, 0
v_pk_max_i16 v225, v225, 0
v_pk_max_i16 v226, v226, 0
v_pk_max_i16 v227, v227, 0
v_pk_fma_f32 v[96:97], v[176:177], v[220:221], v[96:97] op_sel_hi:[1,0,1]
v_pk_fma_f32 v[98:99], v[178:179], v[220:221], v[98:99] op_sel_hi:[1,0,1]
v_pk_fma_f32 v[100:101], v[176:177], v[220:221], v[100:101] op_sel:[0,1,0] op_sel_hi:[1,1,1]
v_pk_fma_f32 v[102:103], v[178:179], v[220:221], v[102:103] op_sel:[0,1,0] op_sel_hi:[1,1,1]
s_add_u32 s63, s70, 4096
v_permlane16_swap_b32 v224, v226
v_permlane16_swap_b32 v225, v227
buffer_store_dwordx4 v[224:227], v210, s[32:35], s63 offen sc1
v_cvt_pk_bf16_f32 v228, v96, v97
v_cvt_pk_bf16_f32 v229, v98, v99
v_cvt_pk_bf16_f32 v230, v100, v101
v_cvt_pk_bf16_f32 v231, v102, v103
v_pk_max_i16 v228, v228, 0
v_pk_max_i16 v229, v229, 0
v_pk_max_i16 v230, v230, 0
v_pk_max_i16 v231, v231, 0
v_pk_fma_f32 v[104:105], v[180:181], v[218:219], v[104:105] op_sel_hi:[1,0,1]
v_pk_fma_f32 v[106:107], v[182:183], v[218:219], v[106:107] op_sel_hi:[1,0,1]
v_pk_fma_f32 v[108:109], v[180:181], v[218:219], v[108:109] op_sel:[0,1,0] op_sel_hi:[1,1,1]
v_pk_fma_f32 v[110:111], v[182:183], v[218:219], v[110:111] op_sel:[0,1,0] op_sel_hi:[1,1,1]
s_add_u32 s63, s70, 4096
v_permlane16_swap_b32 v228, v230
v_permlane16_swap_b32 v229, v231
buffer_store_dwordx4 v[228:231], v211, s[32:35], s63 offen sc1
v_cvt_pk_bf16_f32 v232, v104, v105
v_cvt_pk_bf16_f32 v233, v106, v107
v_cvt_pk_bf16_f32 v234, v108, v109
v_cvt_pk_bf16_f32 v235, v110, v111
v_pk_max_i16 v232, v232, 0
v_pk_max_i16 v233, v233, 0
v_pk_max_i16 v234, v234, 0
v_pk_max_i16 v235, v235, 0
v_pk_fma_f32 v[112:113], v[180:181], v[220:221], v[112:113] op_sel_hi:[1,0,1]
v_pk_fma_f32 v[114:115], v[182:183], v[220:221], v[114:115] op_sel_hi:[1,0,1]
v_pk_fma_f32 v[116:117], v[180:181], v[220:221], v[116:117] op_sel:[0,1,0] op_sel_hi:[1,1,1]
v_pk_fma_f32 v[118:119], v[182:183], v[220:221], v[118:119] op_sel:[0,1,0] op_sel_hi:[1,1,1]
s_add_u32 s63, s71, 6144
v_permlane16_swap_b32 v232, v234
v_permlane16_swap_b32 v233, v235
buffer_store_dwordx4 v[232:235], v210, s[32:35], s63 offen sc1
v_cvt_pk_bf16_f32 v236, v112, v113
v_cvt_pk_bf16_f32 v237, v114, v115
v_cvt_pk_bf16_f32 v238, v116, v117
v_cvt_pk_bf16_f32 v239, v118, v119
v_pk_max_i16 v236, v236, 0
v_pk_max_i16 v237, v237, 0
v_pk_max_i16 v238, v238, 0
v_pk_max_i16 v239, v239, 0
v_pk_fma_f32 v[120:121], v[184:185], v[218:219], v[120:121] op_sel_hi:[1,0,1]
v_pk_fma_f32 v[122:123], v[186:187], v[218:219], v[122:123] op_sel_hi:[1,0,1]
v_pk_fma_f32 v[124:125], v[184:185], v[218:219], v[124:125] op_sel:[0,1,0] op_sel_hi:[1,1,1]
v_pk_fma_f32 v[126:127], v[186:187], v[218:219], v[126:127] op_sel:[0,1,0] op_sel_hi:[1,1,1]
s_add_u32 s63, s71, 6144
v_permlane16_swap_b32 v236, v238
v_permlane16_swap_b32 v237, v239
buffer_store_dwordx4 v[236:239], v211, s[32:35], s63 offen sc1
v_cvt_pk_bf16_f32 v224, v120, v121
v_cvt_pk_bf16_f32 v225, v122, v123
v_cvt_pk_bf16_f32 v226, v124, v125
v_cvt_pk_bf16_f32 v227, v126, v127
v_pk_max_i16 v224, v224, 0
v_pk_max_i16 v225, v225, 0
v_pk_max_i16 v226, v226, 0
v_pk_max_i16 v227, v227, 0
v_pk_fma_f32 v[128:129], v[184:185], v[220:221], v[128:129] op_sel_hi:[1,0,1]
v_pk_fma_f32 v[130:131], v[186:187], v[220:221], v[130:131] op_sel_hi:[1,0,1]
v_pk_fma_f32 v[132:133], v[184:185], v[220:221], v[132:133] op_sel:[0,1,0] op_sel_hi:[1,1,1]
v_pk_fma_f32 v[134:135], v[186:187], v[220:221], v[134:135] op_sel:[0,1,0] op_sel_hi:[1,1,1]
s_add_u32 s63, s71, 8192
v_permlane16_swap_b32 v224, v226
v_permlane16_swap_b32 v225, v227
buffer_store_dwordx4 v[224:227], v210, s[32:35], s63 offen sc1
v_cvt_pk_bf16_f32 v228, v128, v129
v_cvt_pk_bf16_f32 v229, v130, v131
v_cvt_pk_bf16_f32 v230, v132, v133
v_cvt_pk_bf16_f32 v231, v134, v135
v_pk_max_i16 v228, v228, 0
v_pk_max_i16 v229, v229, 0
v_pk_max_i16 v230, v230, 0
v_pk_max_i16 v231, v231, 0
v_pk_fma_f32 v[136:137], v[188:189], v[218:219], v[136:137] op_sel_hi:[1,0,1]
v_pk_fma_f32 v[138:139], v[190:191], v[218:219], v[138:139] op_sel_hi:[1,0,1]
v_pk_fma_f32 v[140:141], v[188:189], v[218:219], v[140:141] op_sel:[0,1,0] op_sel_hi:[1,1,1]
v_pk_fma_f32 v[142:143], v[190:191], v[218:219], v[142:143] op_sel:[0,1,0] op_sel_hi:[1,1,1]
s_add_u32 s63, s71, 8192
v_permlane16_swap_b32 v228, v230
v_permlane16_swap_b32 v229, v231
buffer_store_dwordx4 v[228:231], v211, s[32:35], s63 offen sc1
v_cvt_pk_bf16_f32 v232, v136, v137
v_cvt_pk_bf16_f32 v233, v138, v139
v_cvt_pk_bf16_f32 v234, v140, v141
v_cvt_pk_bf16_f32 v235, v142, v143
v_pk_max_i16 v232, v232, 0
v_pk_max_i16 v233, v233, 0
v_pk_max_i16 v234, v234, 0
v_pk_max_i16 v235, v235, 0
v_pk_fma_f32 v[144:145], v[188:189], v[220:221], v[144:145] op_sel_hi:[1,0,1]
v_pk_fma_f32 v[146:147], v[190:191], v[220:221], v[146:147] op_sel_hi:[1,0,1]
v_pk_fma_f32 v[148:149], v[188:189], v[220:221], v[148:149] op_sel:[0,1,0] op_sel_hi:[1,1,1]
v_pk_fma_f32 v[150:151], v[190:191], v[220:221], v[150:151] op_sel:[0,1,0] op_sel_hi:[1,1,1]
s_add_u32 s63, s71, 10240
v_permlane16_swap_b32 v232, v234
v_permlane16_swap_b32 v233, v235
buffer_store_dwordx4 v[232:235], v210, s[32:35], s63 offen sc1
v_cvt_pk_bf16_f32 v236, v144, v145
v_cvt_pk_bf16_f32 v237, v146, v147
v_cvt_pk_bf16_f32 v238, v148, v149
v_cvt_pk_bf16_f32 v239, v150, v151
v_pk_max_i16 v236, v236, 0
v_pk_max_i16 v237, v237, 0
v_pk_max_i16 v238, v238, 0
v_pk_max_i16 v239, v239, 0
v_pk_fma_f32 v[152:153], v[192:193], v[218:219], v[152:153] op_sel_hi:[1,0,1]
v_pk_fma_f32 v[154:155], v[194:195], v[218:219], v[154:155] op_sel_hi:[1,0,1]
v_pk_fma_f32 v[156:157], v[192:193], v[218:219], v[156:157] op_sel:[0,1,0] op_sel_hi:[1,1,1]
v_pk_fma_f32 v[158:159], v[194:195], v[218:219], v[158:159] op_sel:[0,1,0] op_sel_hi:[1,1,1]
s_add_u32 s63, s71, 10240
v_permlane16_swap_b32 v236, v238
v_permlane16_swap_b32 v237, v239
buffer_store_dwordx4 v[236:239], v211, s[32:35], s63 offen sc1
v_cvt_pk_bf16_f32 v224, v152, v153
v_cvt_pk_bf16_f32 v225, v154, v155
v_cvt_pk_bf16_f32 v226, v156, v157
v_cvt_pk_bf16_f32 v227, v158, v159
v_pk_max_i16 v224, v224, 0
v_pk_max_i16 v225, v225, 0
v_pk_max_i16 v226, v226, 0
v_pk_max_i16 v227, v227, 0
v_pk_fma_f32 v[160:161], v[192:193], v[220:221], v[160:161] op_sel_hi:[1,0,1]
v_pk_fma_f32 v[162:163], v[194:195], v[220:221], v[162:163] op_sel_hi:[1,0,1]
v_pk_fma_f32 v[164:165], v[192:193], v[220:221], v[164:165] op_sel:[0,1,0] op_sel_hi:[1,1,1]
v_pk_fma_f32 v[166:167], v[194:195], v[220:221], v[166:167] op_sel:[0,1,0] op_sel_hi:[1,1,1]
s_add_u32 s63, s71, 12288
v_permlane16_swap_b32 v224, v226
v_permlane16_swap_b32 v225, v227
buffer_store_dwordx4 v[224:227], v210, s[32:35], s63 offen sc1
v_cvt_pk_bf16_f32 v228, v160, v161
v_cvt_pk_bf16_f32 v229, v162, v163
v_cvt_pk_bf16_f32 v230, v164, v165
v_cvt_pk_bf16_f32 v231, v166, v167
v_pk_max_i16 v228, v228, 0
v_pk_max_i16 v229, v229, 0
v_pk_max_i16 v230, v230, 0
v_pk_max_i16 v231, v231, 0
s_add_u32 s63, s71, 12288
v_permlane16_swap_b32 v228, v230
v_permlane16_swap_b32 v229, v231
buffer_store_dwordx4 v[228:231], v211, s[32:35], s63 offen sc1
s_add_u32 m0, s85, 49152
s_nop 0
buffer_load_dwordx4 v12, s[36:39], s76 offen offset:0 lds
buffer_load_dwordx4 v13, s[36:39], s76 offen offset:1024 lds
s_add_u32 s76, s76, 14336
s_cmp_eq_u32 s76, s79
s_cselect_b32 s76, s78, s76
s_add_u32 m0, s85, 57344
s_nop 0
buffer_load_dwordx4 v12, s[36:39], s76 offen offset:0 lds
buffer_load_dwordx4 v13, s[36:39], s76 offen offset:1024 lds
s_add_u32 s76, s76, 14336
s_add_u32 m0, s85, 98304
s_nop 0
buffer_load_dwordx4 v12, s[36:39], s76 offen offset:0 lds
buffer_load_dwordx4 v13, s[36:39], s76 offen offset:1024 lds
s_add_u32 s76, s76, 14336
s_cmp_eq_u32 s76, s79
s_cselect_b32 s76, s78, s76
s_add_u32 m0, s85, 106496
s_nop 0
buffer_load_dwordx4 v12, s[36:39], s76 offen offset:0 lds
buffer_load_dwordx4 v13, s[36:39], s76 offen offset:1024 lds
s_add_u32 s76, s76, 14336
s_waitcnt vmcnt(8)
s_barrier
s_lshl_b32 s63, s2, 7
s_add_u32 s63, s63, 9502720
s_cmp_eq_u32 s3, 0
s_cselect_b32 s63, s63, 0x80000000
v_lshl_add_u32 v8, v0, 2, s63
v_mov_b32 v9, s86
s_mov_b32 exec_hi, 0
buffer_store_dword v9, v8, s[32:35], 0 offen sc1
s_mov_b64 exec, -1
s_mov_b32 s24, s4
s_mov_b32 s25, s5
s_mov_b32 s26, 1835008
s_mov_b32 s64, 13312
s_add_u32 m0, s85, 155648
s_nop 0
buffer_load_dwordx4 v26, s[24:27], 0 offen offset:0 lds
buffer_load_dwordx4 v26, s[24:27], s64 offen offset:1024 lds
ds_read_b64_tr_b16 a[160:161], v16 offset:49152
s_add_u32 m0, s85, 0
ds_read_b64_tr_b16 a[162:163], v16 offset:49664
ds_read_b64_tr_b16 a[164:165], v17 offset:49152
ds_read_b64_tr_b16 a[166:167], v17 offset:49664
buffer_load_dwordx4 v12, s[36:39], s76 offen offset:0 lds
ds_read_b64_tr_b16 a[192:193], v22 offset:49152
ds_read_b64_tr_b16 a[194:195], v22 offset:49664
ds_read_b64_tr_b16 a[196:197], v23 offset:49152
ds_read_b64_tr_b16 a[198:199], v23 offset:49664
buffer_load_dwordx4 v13, s[36:39], s76 offen offset:1024 lds
ds_read_b64_tr_b16 a[168:169], v16 offset:57344
ds_read_b64_tr_b16 a[170:171], v16 offset:57856
ds_read_b64_tr_b16 a[172:173], v17 offset:57344
s_add_u32 s76, s76, 14336
ds_read_b64_tr_b16 a[174:175], v17 offset:57856
ds_read_b64_tr_b16 a[200:201], v22 offset:57344
ds_read_b64_tr_b16 a[202:203], v22 offset:57856
ds_read_b64_tr_b16 a[204:205], v23 offset:57344
s_cmp_eq_u32 s76, s79
s_cselect_b32 s76, s78, s76
ds_read_b64_tr_b16 a[206:207], v23 offset:57856
ds_read_b64_tr_b16 a[176:177], v18 offset:0
ds_read_b64_tr_b16 a[178:179], v18 offset:512
s_add_u32 m0, s85, 8192
ds_read_b64_tr_b16 a[180:181], v19 offset:0
ds_read_b64_tr_b16 a[182:183], v19 offset:512
ds_read_b64_tr_b16 a[208:209], v24 offset:0
ds_read_b64_tr_b16 a[210:211], v24 offset:512
buffer_load_dwordx4 v12, s[40:43], s77 offen offset:0 lds
ds_read_b64_tr_b16 a[212:213], v25 offset:0
ds_read_b64_tr_b16 a[214:215], v25 offset:512
ds_read_b64_tr_b16 a[184:185], v18 offset:8192
buffer_load_dwordx4 v13, s[40:43], s77 offen offset:1024 lds
ds_read_b64_tr_b16 a[186:187], v18 offset:8704
ds_read_b64_tr_b16 a[188:189], v19 offset:8192
ds_read_b64_tr_b16 a[190:191], v19 offset:8704
ds_read_b64_tr_b16 a[216:217], v24 offset:8192
s_add_u32 s77, s77, 14336
ds_read_b64_tr_b16 a[218:219], v24 offset:8704
ds_read_b64_tr_b16 a[220:221], v25 offset:8192
ds_read_b64_tr_b16 a[222:223], v25 offset:8704
s_waitcnt lgkmcnt(0)
s_barrier
s_add_u32 m0, s85, 16384
s_nop 0
buffer_load_dwordx4 v12, s[40:43], s77 offen offset:0 lds
buffer_load_dwordx4 v13, s[40:43], s77 offen offset:1024 lds
s_add_u32 s77, s77, 10752
s_cmp_eq_u32 s77, s81
s_cselect_b32 s77, s80, s77
s_add_u32 m0, s85, 24576
s_nop 0
buffer_load_dwordx4 v12, s[40:43], s77 offen offset:0 lds
buffer_load_dwordx4 v13, s[40:43], s77 offen offset:1024 lds
s_add_u32 s77, s77, 14336
buffer_load_dword v32, v27, s[32:35], 0 offen sc1
s_add_u32 m0, s85, 65536
s_nop 0
buffer_load_dwordx4 v12, s[40:43], s77 offen offset:0 lds
buffer_load_dwordx4 v13, s[40:43], s77 offen offset:1024 lds
s_add_u32 s77, s77, 10752
s_cmp_eq_u32 s77, s81
s_cselect_b32 s77, s80, s77
s_add_u32 m0, s85, 73728
s_nop 0
buffer_load_dwordx4 v12, s[40:43], s77 offen offset:0 lds
buffer_load_dwordx4 v13, s[40:43], s77 offen offset:1024 lds
s_add_u32 s77, s77, 14336
s_add_u32 m0, s85, 114688
s_nop 0
buffer_load_dwordx4 v12, s[40:43], s77 offen offset:0 lds
buffer_load_dwordx4 v13, s[40:43], s77 offen offset:1024 lds
s_add_u32 s77, s77, 10752
s_cmp_eq_u32 s77, s81
s_cselect_b32 s77, s80, s77
s_add_u32 m0, s85, 122880
s_nop 0
buffer_load_dwordx4 v12, s[40:43], s77 offen offset:0 lds
buffer_load_dwordx4 v13, s[40:43], s77 offen offset:1024 lds
s_add_u32 s77, s77, 14336
s_add_u32 m0, s85, 131072
s_nop 0
buffer_load_dwordx4 v12, s[40:43], s77 offen offset:0 lds
buffer_load_dwordx4 v13, s[40:43], s77 offen offset:1024 lds
s_add_u32 s77, s77, 10752
s_cmp_eq_u32 s77, s81
s_cselect_b32 s77, s80, s77
s_waitcnt vmcnt(10)
v_cmp_eq_u32 vcc, s86, v32
s_and_b32 s63, vcc_lo, 3
s_cmp_lg_u32 s63, 3
s_cbranch_scc1 PF_F_S
PF_F_X:
buffer_load_dwordx4 v[208:211], v10, s[32:35], s66 offen offset:0 sc1
buffer_load_dwordx4 v[212:215], v10, s[32:35], s66 offen offset:2048 sc1
buffer_load_dwordx4 v[216:219], v10, s[32:35], s6 offen offset:0 sc1
buffer_load_dwordx4 v[220:223], v10, s[32:35], s6 offen offset:2048 sc1
buffer_load_dwordx4 v[224:227], v10, s[32:35], s7 offen offset:0 sc1
buffer_load_dwordx4 v[228:231], v10, s[32:35], s7 offen offset:2048 sc1
buffer_load_dwordx4 v[232:235], v10, s[32:35], s8 offen offset:0 sc1
buffer_load_dwordx4 v[236:239], v10, s[32:35], s8 offen offset:2048 sc1
buffer_load_dwordx4 v[240:243], v10, s[32:35], s9 offen offset:0 sc1
buffer_load_dwordx4 v[244:247], v10, s[32:35], s9 offen offset:2048 sc1
s_waitcnt vmcnt(63) lgkmcnt(0)
s_waitcnt vmcnt(8)
v_mfma_f32_32x32x16_bf16 v[56:71], a[164:167], v[208:211], 0
ds_read_b64_tr_b16 a[0:1], v18 offset:16384
ds_read_b64_tr_b16 a[2:3], v18 offset:16896
buffer_load_dwordx4 v[248:251], v10, s[32:35], s10 offen offset:0 sc1
v_and_b32 v6, 31, v0
v_lshrrev_b32 v7, 5, v0
v_mfma_f32_32x32x16_bf16 v[40:55], a[160:163], v[208:211], 0
ds_read_b64_tr_b16 a[4:5], v19 offset:16384
ds_read_b64_tr_b16 a[6:7], v19 offset:16896
ds_read_b64_tr_b16 a[8:9], v16 offset:16384
v_lshlrev_b32 v159, 4, v0
v_mfma_f32_32x32x16_bf16 v[56:71], a[172:175], v[212:215], v[56:71]
ds_read_b64_tr_b16 a[10:11], v16 offset:16896
buffer_load_dwordx4 v[252:255], v10, s[32:35], s10 offen offset:2048 sc1
ds_read_b64_tr_b16 a[12:13], v17 offset:16384
s_and_b32 s70, s74, 1
ds_read_b64_tr_b16 a[14:15], v17 offset:16896
v_mfma_f32_32x32x16_bf16 v[40:55], a[168:171], v[212:215], v[40:55]
s_waitcnt vmcnt(8)
v_mfma_f32_32x32x16_bf16 v[56:71], a[180:183], v[216:219], v[56:71]
ds_read_b64_tr_b16 a[16:17], v16 offset:24576
ds_read_b64_tr_b16 a[18:19], v16 offset:25088
buffer_load_dwordx4 v[208:211], v10, s[32:35], s11 offen offset:0 sc1
s_mul_i32 s70, s70, 589824
s_sub_u32 s70, s70, 294912
v_mfma_f32_32x32x16_bf16 v[40:55], a[176:179], v[216:219], v[40:55]
ds_read_b64_tr_b16 a[20:21], v17 offset:24576
ds_read_b64_tr_b16 a[22:23], v17 offset:25088
v_add_u32 v174, s70, v10
v_add_u32 v175, s70, v11
v_mfma_f32_32x32x16_bf16 v[56:71], a[188:191], v[220:223], v[56:71]
ds_read_b64_tr_b16 a[24:25], v14 offset:32768
ds_read_b64_tr_b16 a[26:27], v14 offset:33280
buffer_load_dwordx4 v[212:215], v10, s[32:35], s11 offen offset:2048 sc1
ds_read_b64_tr_b16 a[28:29], v15 offset:32768
s_mul_i32 s70, s74, 288
v_mfma_f32_32x32x16_bf16 v[40:55], a[184:187], v[220:223], v[40:55]
ds_read_b64_tr_b16 a[30:31], v15 offset:33280
s_waitcnt vmcnt(8)
s_waitcnt lgkmcnt(8)
v_mfma_f32_32x32x16_bf16 v[56:71], a[4:7], v[224:227], v[56:71]
ds_read_b64_tr_b16 a[32:33], v14 offset:40960
ds_read_b64_tr_b16 a[34:35], v14 offset:41472
buffer_load_dwordx4 v[216:219], v11, s[32:35], s66 offen offset:0 sc1
s_add_u32 s70, s70, s72
s_lshl_b32 s70, s70, 10
v_mfma_f32_32x32x16_bf16 v[40:55], a[0:3], v[224:227], v[40:55]
ds_read_b64_tr_b16 a[36:37], v15 offset:40960
ds_read_b64_tr_b16 a[38:39], v15 offset:41472
ds_read_b64_tr_b16 a[40:41], v14 offset:49152
v_add_u32 v3, s70, v159
v_mfma_f32_32x32x16_bf16 v[56:71], a[12:15], v[228:231], v[56:71]
ds_read_b64_tr_b16 a[42:43], v14 offset:49664
buffer_load_dwordx4 v[220:223], v11, s[32:35], s66 offen offset:2048 sc1
ds_read_b64_tr_b16 a[44:45], v15 offset:49152
s_lshl_b32 s70, s3, 14
ds_read_b64_tr_b16 a[46:47], v15 offset:49664
v_mfma_f32_32x32x16_bf16 v[40:55], a[8:11], v[228:231], v[40:55]
s_waitcnt vmcnt(8)
s_waitcnt lgkmcnt(8)
v_mfma_f32_32x32x16_bf16 v[56:71], a[20:23], v[232:235], v[56:71]
ds_read_b64_tr_b16 a[48:49], v14 offset:57344
ds_read_b64_tr_b16 a[50:51], v14 offset:57856
buffer_load_dwordx4 v[224:227], v11, s[32:35], s6 offen offset:0 sc1
v_add_u32 v176, s70, v3
s_xor_b32 s70, s70, 16384
v_mfma_f32_32x32x16_bf16 v[40:55], a[16:19], v[232:235], v[40:55]
ds_read_b64_tr_b16 a[52:53], v15 offset:57344
ds_read_b64_tr_b16 a[54:55], v15 offset:57856
v_add_u32 v177, s70, v3
s_lshl_b32 s70, s2, 2
v_mfma_f32_32x32x16_bf16 v[56:71], a[28:31], v[236:239], v[56:71]
ds_read_b64_tr_b16 a[56:57], v16 offset:32768
ds_read_b64_tr_b16 a[58:59], v16 offset:33280
buffer_load_dwordx4 v[228:231], v11, s[32:35], s6 offen offset:2048 sc1
ds_read_b64_tr_b16 a[60:61], v17 offset:32768
s_add_u32 s70, s70, s3
v_mfma_f32_32x32x16_bf16 v[40:55], a[24:27], v[236:239], v[40:55]
ds_read_b64_tr_b16 a[62:63], v17 offset:33280
s_waitcnt vmcnt(8)
s_waitcnt lgkmcnt(8)
v_mfma_f32_32x32x16_bf16 v[56:71], a[36:39], v[240:243], v[56:71]
ds_read_b64_tr_b16 a[64:65], v16 offset:40960
ds_read_b64_tr_b16 a[66:67], v16 offset:41472
buffer_load_dwordx4 v[232:235], v11, s[32:35], s7 offen offset:0 sc1
s_mul_i32 s71, s70, 3072
PADF3:
s_cbranch_execz BACK_F
s_add_u32 s71, s71, 10059776
v_mfma_f32_32x32x16_bf16 v[40:55], a[32:35], v[240:243], v[40:55]
ds_read_b64_tr_b16 a[68:69], v17 offset:40960
ds_read_b64_tr_b16 a[70:71], v17 offset:41472
ds_read_b64_tr_b16 a[72:73], v14 offset:0
v_add_u32 v171, s71, v159
v_mfma_f32_32x32x16_bf16 v[56:71], a[44:47], v[244:247], v[56:71]
ds_read_b64_tr_b16 a[74:75], v14 offset:512
buffer_load_dwordx4 v[236:239], v11, s[32:35], s7 offen offset:2048 sc1
ds_read_b64_tr_b16 a[76:77], v15 offset:0
s_xor_b32 s71, s70, 4
ds_read_b64_tr_b16 a[78:79], v15 offset:512
v_mfma_f32_32x32x16_bf16 v[40:55], a[40:43], v[244:247], v[40:55]
s_waitcnt vmcnt(8)
s_waitcnt lgkmcnt(8)
v_mfma_f32_32x32x16_bf16 v[56:71], a[52:55], v[248:251], v[56:71]
buffer_load_dwordx4 v[240:243], v11, s[32:35], s8 offen offset:0 sc1
s_mul_i32 s71, s71, 3072
s_add_u32 s71, s71, 10059776
v_add_u32 v170, s71, v159
v_mfma_f32_32x32x16_bf16 v[40:55], a[48:51], v[248:251], v[40:55]
v_mov_b32 v139, s86
buffer_load_dwordx4 v[244:247], v11, s[32:35], s8 offen offset:2048 sc1
v_mfma_f32_32x32x16_bf16 v[56:71], a[60:63], v[252:255], v[56:71]
v_mov_b32 v143, s86
v_mfma_f32_32x32x16_bf16 v[40:55], a[56:59], v[252:255], v[40:55]
s_waitcnt vmcnt(8)
s_waitcnt lgkmcnt(0)
v_mfma_f32_32x32x16_bf16 v[56:71], a[68:71], v[208:211], v[56:71]
buffer_load_dwordx4 v[248:251], v11, s[32:35], s9 offen offset:0 sc1
v_mov_b32 v147, s86
s_mov_b32 s28, s16
v_mfma_f32_32x32x16_bf16 v[40:55], a[64:67], v[208:211], v[40:55]
s_mov_b32 s29, s17
buffer_load_dwordx4 v[252:255], v11, s[32:35], s9 offen offset:2048 sc1
v_mfma_f32_32x32x16_bf16 v[56:71], a[76:79], v[212:215], v[56:71]
s_mov_b32 s30, 1835008
v_mfma_f32_32x32x16_bf16 v[40:55], a[72:75], v[212:215], v[40:55]
s_waitcnt vmcnt(8)
s_barrier
v_mfma_f32_32x32x16_bf16 v[56:71], a[196:199], v[216:219], v[56:71]
ds_read_b64_tr_b16 a[80:81], v24 offset:16384
ds_read_b64_tr_b16 a[82:83], v24 offset:16896
buffer_load_dwordx4 v[208:211], v11, s[32:35], s10 offen offset:0 sc1
s_lshl_b32 s71, s72, 12
s_add_u32 s71, s71, 155648
v_mfma_f32_32x32x16_bf16 v[40:55], a[192:195], v[216:219], v[40:55]
ds_read_b64_tr_b16 a[84:85], v25 offset:16384
ds_read_b64_tr_b16 a[86:87], v25 offset:16896
v_lshlrev_b32 v3, 7, v6
v_lshl_add_u32 v3, v7, 3, v3
v_mfma_f32_32x32x16_bf16 v[56:71], a[204:207], v[220:223], v[56:71]
ds_read_b64_tr_b16 a[88:89], v22 offset:16384
ds_read_b64_tr_b16 a[90:91], v22 offset:16896
buffer_load_dwordx4 v[212:215], v11, s[32:35], s10 offen offset:2048 sc1
ds_read_b64_tr_b16 a[92:93], v23 offset:16384
s_lshl_b32 s68, s73, 2
v_mfma_f32_32x32x16_bf16 v[40:55], a[200:203], v[220:223], v[40:55]
ds_read_b64_tr_b16 a[94:95], v23 offset:16896
s_waitcnt vmcnt(8)
v_mfma_f32_32x32x16_bf16 v[56:71], a[212:215], v[224:227], v[56:71]
ds_read_b64_tr_b16 a[96:97], v22 offset:24576
ds_read_b64_tr_b16 a[98:99], v22 offset:25088
buffer_load_dwordx4 v[216:219], v11, s[32:35], s11 offen offset:0 sc1
v_and_b32 v4, 7, v0
v_xor_b32 v4, s68, v4
v_mfma_f32_32x32x16_bf16 v[40:55], a[208:211], v[224:227], v[40:55]
ds_read_b64_tr_b16 a[100:101], v23 offset:24576
ds_read_b64_tr_b16 a[102:103], v23 offset:25088
ds_read_b64_tr_b16 a[104:105], v20 offset:32768
v_lshl_add_u32 v3, v4, 4, v3
v_mfma_f32_32x32x16_bf16 v[56:71], a[220:223], v[228:231], v[56:71]
ds_read_b64_tr_b16 a[106:107], v20 offset:33280
buffer_load_dwordx4 v[220:223], v11, s[32:35], s11 offen offset:2048 sc1
ds_read_b64_tr_b16 a[108:109], v21 offset:32768
v_add_u32 v168, s71, v3
v_mfma_f32_32x32x16_bf16 v[40:55], a[216:219], v[228:231], v[40:55]
ds_read_b64_tr_b16 a[110:111], v21 offset:33280
s_waitcnt vmcnt(8)
s_waitcnt lgkmcnt(8)
v_mfma_f32_32x32x16_bf16 v[56:71], a[84:87], v[232:235], v[56:71]
ds_read_b64_tr_b16 a[112:113], v20 offset:40960
ds_read_b64_tr_b16 a[114:115], v20 offset:41472
buffer_load_dwordx4 v[224:227], v174, s[32:35], s66 offen offset:0 sc1
s_mul_i32 s71, s72, 57344
s_add_u32 s71, s71, s84
v_mfma_f32_32x32x16_bf16 v[40:55], a[80:83], v[232:235], v[40:55]
ds_read_b64_tr_b16 a[116:117], v21 offset:40960
ds_read_b64_tr_b16 a[118:119], v21 offset:41472
s_lshl_b32 s68, s73, 6
ds_read_b64_tr_b16 a[120:121], v20 offset:49152
v_mfma_f32_32x32x16_bf16 v[56:71], a[92:95], v[236:239], v[56:71]
ds_read_b64_tr_b16 a[122:123], v20 offset:49664
buffer_load_dwordx4 v[228:231], v174, s[32:35], s66 offen offset:2048 sc1
ds_read_b64_tr_b16 a[124:125], v21 offset:49152
s_add_u32 s71, s71, s68
ds_read_b64_tr_b16 a[126:127], v21 offset:49664
v_mfma_f32_32x32x16_bf16 v[40:55], a[88:91], v[236:239], v[40:55]
v_mul_u32_u24 v3, 1792, v6
s_waitcnt vmcnt(8)
s_waitcnt lgkmcnt(8)
v_mfma_f32_32x32x16_bf16 v[56:71], a[100:103], v[240:243], v[56:71]
ds_read_b64_tr_b16 a[128:129], v20 offset:57344
ds_read_b64_tr_b16 a[130:131], v20 offset:57856
buffer_load_dwordx4 v[232:235], v174, s[32:35], s6 offen offset:0 sc1
v_add_u32 v3, s71, v3
v_lshl_add_u32 v158, v7, 4, v3
v_mfma_f32_32x32x16_bf16 v[40:55], a[96:99], v[240:243], v[40:55]
ds_read_b64_tr_b16 a[132:133], v21 offset:57344
ds_read_b64_tr_b16 a[134:135], v21 offset:57856
ds_read_b64_tr_b16 a[136:137], v22 offset:32768
s_lshl_b32 s71, s74, 1
v_mfma_f32_32x32x16_bf16 v[56:71], a[108:111], v[244:247], v[56:71]
ds_read_b64_tr_b16 a[138:139], v22 offset:33280
buffer_load_dwordx4 v[236:239], v174, s[32:35], s6 offen offset:2048 sc1
ds_read_b64_tr_b16 a[140:141], v23 offset:32768
s_add_u32 s71, s71, s72
ds_read_b64_tr_b16 a[142:143], v23 offset:33280
v_mfma_f32_32x32x16_bf16 v[40:55], a[104:107], v[244:247], v[40:55]
s_waitcnt vmcnt(8)
s_waitcnt lgkmcnt(8)
v_mfma_f32_32x32x16_bf16 v[56:71], a[116:119], v[248:251], v[56:71]
ds_read_b64_tr_b16 a[144:145], v22 offset:40960
ds_read_b64_tr_b16 a[146:147], v22 offset:41472
buffer_load_dwordx4 v[240:243], v174, s[32:35], s7 offen offset:0 sc1
s_lshl_b32 s71, s71, 7
s_lshl_b32 s68, s3, 14
v_mfma_f32_32x32x16_bf16 v[40:55], a[112:115], v[248:251], v[40:55]
ds_read_b64_tr_b16 a[148:149], v23 offset:40960
ds_read_b64_tr_b16 a[150:151], v23 offset:41472
s_add_u32 s71, s71, s68
ds_read_b64_tr_b16 a[152:153], v20 offset:0
v_mfma_f32_32x32x16_bf16 v[56:71], a[124:127], v[252:255], v[56:71]
ds_read_b64_tr_b16 a[154:155], v20 offset:512
buffer_load_dwordx4 v[244:247], v174, s[32:35], s7 offen offset:2048 sc1
ds_read_b64_tr_b16 a[156:157], v21 offset:0
s_add_u32 s71, s71, 9437184
ds_read_b64_tr_b16 a[158:159], v21 offset:512
v_mfma_f32_32x32x16_bf16 v[40:55], a[120:123], v[252:255], v[40:55]
v_lshl_add_u32 v169, v6, 2, s71
s_waitcnt vmcnt(8)
s_waitcnt lgkmcnt(8)
v_mfma_f32_32x32x16_bf16 v[56:71], a[132:135], v[208:211], v[56:71]
buffer_load_dwordx4 v[248:251], v174, s[32:35], s8 offen offset:0 sc1
s_add_u32 s71, s85, 0
v_add_u32 v172, s71, v159
v_xor_b32 v173, 4096, v172
v_mfma_f32_32x32x16_bf16 v[40:55], a[128:131], v[208:211], v[40:55]
s_mov_b32 s70, 0x3f80
buffer_load_dwordx4 v[252:255], v174, s[32:35], s8 offen offset:2048 sc1
v_mfma_f32_32x32x16_bf16 v[56:71], a[140:143], v[212:215], v[56:71]
s_mov_b32 s71, 0x3f800000
v_mfma_f32_32x32x16_bf16 v[40:55], a[136:139], v[212:215], v[40:55]
s_waitcnt vmcnt(8)
s_waitcnt lgkmcnt(0)
v_mfma_f32_32x32x16_bf16 v[56:71], a[148:151], v[216:219], v[56:71]
buffer_load_dwordx4 v[208:211], v174, s[32:35], s9 offen offset:0 sc1
v_mfma_f32_32x32x16_bf16 v[56:71], a[156:159], v[220:223], v[56:71]
buffer_load_dwordx4 v[212:215], v174, s[32:35], s9 offen offset:2048 sc1
v_mfma_f32_32x32x16_bf16 v[40:55], a[144:147], v[216:219], v[40:55]
v_mfma_f32_32x32x16_bf16 v[40:55], a[152:155], v[220:223], v[40:55]
s_waitcnt vmcnt(8)
s_barrier
v_mfma_f32_32x32x16_bf16 v[88:103], a[164:167], v[224:227], 0
buffer_load_dwordx4 v[216:219], v174, s[32:35], s10 offen offset:0 sc1
v_mfma_f32_32x32x16_bf16 v[72:87], a[160:163], v[224:227], 0
s_nop 3
ds_write_b128 v172, v[56:59] offset:49152
buffer_load_dwordx4 v[220:223], v174, s[32:35], s10 offen offset:2048 sc1
v_mfma_f32_32x32x16_bf16 v[88:103], a[172:175], v[228:231], v[88:103]
v_mfma_f32_32x32x16_bf16 v[72:87], a[168:171], v[228:231], v[72:87]
ds_write_b128 v172, v[60:63] offset:50176
s_waitcnt vmcnt(8)
v_mfma_f32_32x32x16_bf16 v[88:103], a[180:183], v[232:235], v[88:103]
buffer_load_dwordx4 v[224:227], v174, s[32:35], s11 offen offset:0 sc1
v_mfma_f32_32x32x16_bf16 v[72:87], a[176:179], v[232:235], v[72:87]
ds_write_b128 v172, v[64:67] offset:57344
buffer_load_dwordx4 v[228:231], v174, s[32:35], s11 offen offset:2048 sc1
v_mfma_f32_32x32x16_bf16 v[88:103], a[188:191], v[236:239], v[88:103]
v_mfma_f32_32x32x16_bf16 v[72:87], a[184:187], v[236:239], v[72:87]
ds_write_b128 v172, v[68:71] offset:58368
s_waitcnt vmcnt(8)
s_waitcnt lgkmcnt(0)
s_barrier
v_mfma_f32_32x32x16_bf16 v[88:103], a[4:7], v[240:243], v[88:103]
ds_read_b128 v[56:59], v173 offset:49152
buffer_load_dwordx4 v[232:235], v175, s[32:35], s66 offen offset:0 sc1
ds_read_b128 v[60:63], v173 offset:50176
v_mfma_f32_32x32x16_bf16 v[72:87], a[0:3], v[240:243], v[72:87]
ds_read_b128 v[64:67], v173 offset:57344
buffer_load_dwordx4 v[236:239], v175, s[32:35], s66 offen offset:2048 sc1
v_mfma_f32_32x32x16_bf16 v[88:103], a[12:15], v[244:247], v[88:103]
ds_read_b128 v[68:71], v173 offset:58368
v_mfma_f32_32x32x16_bf16 v[72:87], a[8:11], v[244:247], v[72:87]
s_waitcnt vmcnt(8)
v_mfma_f32_32x32x16_bf16 v[88:103], a[20:23], v[248:251], v[88:103]
buffer_load_dwordx4 v[240:243], v175, s[32:35], s6 offen offset:0 sc1
s_waitcnt lgkmcnt(0)
v_add_f32 v40, v40, v56
v_add_f32 v41, v41, v57
v_cvt_pk_bf16_f32 v136, v40, v41
v_add_f32 v42, v42, v58
v_mfma_f32_32x32x16_bf16 v[72:87], a[16:19], v[248:251], v[72:87]
v_add_f32 v43, v43, v59
v_cvt_pk_bf16_f32 v137, v42, v43
v_add_f32 v44, v44, v60
v_add_f32 v45, v45, v61
v_cvt_pk_bf16_f32 v138, v44, v45
v_mfma_f32_32x32x16_bf16 v[88:103], a[28:31], v[252:255], v[88:103]
buffer_load_dwordx4 v[244:247], v175, s[32:35], s6 offen offset:2048 sc1
buffer_store_dwordx4 v[136:139], v170, s[32:35], 0 offen offset:0 sc1
v_add_f32 v46, v46, v62
v_add_f32 v47, v47, v63
v_cvt_pk_bf16_f32 v140, v46, v47
v_mfma_f32_32x32x16_bf16 v[72:87], a[24:27], v[252:255], v[72:87]
s_waitcnt vmcnt(9)
v_mfma_f32_32x32x16_bf16 v[88:103], a[36:39], v[208:211], v[88:103]
buffer_load_dwordx4 v[248:251], v175, s[32:35], s7 offen offset:0 sc1
v_add_f32 v48, v48, v64
v_add_f32 v49, v49, v65
v_cvt_pk_bf16_f32 v141, v48, v49
v_add_f32 v50, v50, v66
v_add_f32 v51, v51, v67
v_mfma_f32_32x32x16_bf16 v[72:87], a[32:35], v[208:211], v[72:87]
v_cvt_pk_bf16_f32 v142, v50, v51
buffer_store_dwordx4 v[140:143], v170, s[32:35], 0 offen offset:1024 sc1
v_add_f32 v52, v52, v68
v_add_f32 v53, v53, v69
v_mfma_f32_32x32x16_bf16 v[88:103], a[44:47], v[212:215], v[88:103]
buffer_load_dwordx4 v[252:255], v175, s[32:35], s7 offen offset:2048 sc1
v_cvt_pk_bf16_f32 v144, v52, v53
v_add_f32 v54, v54, v70
v_add_f32 v55, v55, v71
v_cvt_pk_bf16_f32 v145, v54, v55
v_mfma_f32_32x32x16_bf16 v[72:87], a[40:43], v[212:215], v[72:87]
buffer_store_dwordx4 v[144:147], v170, s[32:35], 0 offen offset:2048 sc1
s_waitcnt vmcnt(11)
v_mfma_f32_32x32x16_bf16 v[88:103], a[52:55], v[216:219], v[88:103]
ds_read_b64_tr_b16 a[160:161], v14 offset:8192
buffer_load_dword v32, v27, s[32:35], 0 offen sc1
ds_read_b64_tr_b16 a[162:163], v14 offset:8704
ds_read_b64_tr_b16 a[164:165], v15 offset:8192
buffer_load_dwordx4 v[208:211], v175, s[32:35], s8 offen offset:0 sc1
v_mfma_f32_32x32x16_bf16 v[72:87], a[48:51], v[216:219], v[72:87]
ds_read_b64_tr_b16 a[166:167], v15 offset:8704
ds_read_b64_tr_b16 a[168:169], v14 offset:16384
ds_read_b64_tr_b16 a[170:171], v14 offset:16896
buffer_load_dwordx4 v[212:215], v175, s[32:35], s8 offen offset:2048 sc1
v_mfma_f32_32x32x16_bf16 v[88:103], a[60:63], v[220:223], v[88:103]
ds_read_b64_tr_b16 a[172:173], v15 offset:16384
ds_read_b64_tr_b16 a[174:175], v15 offset:16896
v_mfma_f32_32x32x16_bf16 v[72:87], a[56:59], v[220:223], v[72:87]
s_waitcnt vmcnt(12)
v_mfma_f32_32x32x16_bf16 v[88:103], a[68:71], v[224:227], v[88:103]
ds_read_b64_tr_b16 a[176:177], v14 offset:24576
ds_read_b64_tr_b16 a[178:179], v14 offset:25088
buffer_load_dwordx4 v[216:219], v175, s[32:35], s9 offen offset:0 sc1
v_xor_b32 v3, 0, v168
v_mfma_f32_32x32x16_bf16 v[72:87], a[64:67], v[224:227], v[72:87]
ds_read_b64 v[148:149], v3
ds_read_b64_tr_b16 a[180:181], v15 offset:24576
ds_read_b64_tr_b16 a[182:183], v15 offset:25088
v_xor_b32 v3, 16, v168
v_mfma_f32_32x32x16_bf16 v[88:103], a[76:79], v[228:231], v[88:103]
ds_read_b64 v[150:151], v3
ds_read_b64_tr_b16 a[184:185], v16 offset:0
ds_read_b64_tr_b16 a[186:187], v16 offset:512
buffer_load_dwordx4 v[220:223], v175, s[32:35], s9 offen offset:2048 sc1
v_mfma_f32_32x32x16_bf16 v[72:87], a[72:75], v[228:231], v[72:87]
ds_read_b64_tr_b16 a[188:189], v17 offset:0
ds_read_b64_tr_b16 a[190:191], v17 offset:512
v_xor_b32 v3, 32, v168
ds_read_b64 v[152:153], v3
v_xor_b32 v3, 48, v168
ds_read_b64 v[154:155], v3
s_waitcnt vmcnt(12)
v_mfma_f32_32x32x16_bf16 v[88:103], a[196:199], v[232:235], v[88:103]
ds_read_b64_tr_b16 a[0:1], v16 offset:8192
ds_read_b64_tr_b16 a[2:3], v16 offset:8704
buffer_load_dwordx4 v[224:227], v175, s[32:35], s10 offen offset:0 sc1
s_waitcnt lgkmcnt(2)
v_lshlrev_b32 v56, 16, v148
v_mfma_f32_32x32x16_bf16 v[72:87], a[192:195], v[232:235], v[72:87]
ds_read_b64_tr_b16 a[4:5], v17 offset:8192
ds_read_b64_tr_b16 a[6:7], v17 offset:8704
v_and_b32 v57, 0xffff0000, v148
v_lshlrev_b32 v58, 16, v149
v_and_b32 v59, 0xffff0000, v149
v_mfma_f32_32x32x16_bf16 v[88:103], a[204:207], v[236:239], v[88:103]
ds_read_b64_tr_b16 a[8:9], v16 offset:49152
ds_read_b64_tr_b16 a[10:11], v16 offset:49664
buffer_load_dwordx4 v[228:231], v175, s[32:35], s10 offen offset:2048 sc1
ds_read_b64_tr_b16 a[12:13], v17 offset:49152
v_lshlrev_b32 v60, 16, v150
v_mfma_f32_32x32x16_bf16 v[72:87], a[200:203], v[236:239], v[72:87]
ds_read_b64_tr_b16 a[14:15], v17 offset:49664
v_and_b32 v61, 0xffff0000, v150
v_lshlrev_b32 v62, 16, v151
v_and_b32 v63, 0xffff0000, v151
s_waitcnt vmcnt(12)
v_mfma_f32_32x32x16_bf16 v[88:103], a[212:215], v[240:243], v[88:103]
ds_read_b64_tr_b16 a[16:17], v16 offset:57344
ds_read_b64_tr_b16 a[18:19], v16 offset:57856
buffer_load_dwordx4 v[232:235], v175, s[32:35], s11 offen offset:0 sc1
v_lshlrev_b32 v64, 16, v152
v_and_b32 v65, 0xffff0000, v152
v_mfma_f32_32x32x16_bf16 v[72:87], a[208:211], v[240:243], v[72:87]
ds_read_b64_tr_b16 a[20:21], v17 offset:57344
ds_read_b64_tr_b16 a[22:23], v17 offset:57856
v_lshlrev_b32 v66, 16, v153
v_and_b32 v67, 0xffff0000, v153
v_lshlrev_b32 v68, 16, v154
v_mfma_f32_32x32x16_bf16 v[88:103], a[220:223], v[244:247], v[88:103]
ds_read_b64_tr_b16 a[24:25], v18 offset:0
ds_read_b64_tr_b16 a[26:27], v18 offset:512
buffer_load_dwordx4 v[236:239], v175, s[32:35], s11 offen offset:2048 sc1
ds_read_b64_tr_b16 a[28:29], v19 offset:0
v_and_b32 v69, 0xffff0000, v154
v_mfma_f32_32x32x16_bf16 v[72:87], a[216:219], v[244:247], v[72:87]
ds_read_b64_tr_b16 a[30:31], v19 offset:512
v_lshlrev_b32 v70, 16, v155
v_and_b32 v71, 0xffff0000, v155
s_waitcnt vmcnt(10)
v_mfma_f32_32x32x16_bf16 v[88:103], a[84:87], v[248:251], v[88:103]
ds_read_b64_tr_b16 a[32:33], v20 offset:8192
ds_read_b64_tr_b16 a[34:35], v20 offset:8704
ds_read_b64_tr_b16 a[36:37], v21 offset:8192
v_mfma_f32_32x32x16_bf16 v[72:87], a[80:83], v[248:251], v[72:87]
ds_read_b64_tr_b16 a[38:39], v21 offset:8704
s_waitcnt vmcnt(8)
v_cmp_eq_u32 vcc, s86, v32
s_and_b32 s63, vcc_lo, 60
s_cmp_lg_u32 s63, 60
s_cbranch_scc1 PS_F_S
PS_F_X:
v_mfma_f32_32x32x16_bf16 v[88:103], a[92:95], v[252:255], v[88:103]
buffer_load_dword v156, v169, s[32:35], 0 offen sc1
ds_read_b64_tr_b16 a[40:41], v20 offset:16384
buffer_load_dwordx4 v[240:243], v176, s[32:35], s12 offen offset:0 sc1
ds_read_b64_tr_b16 a[42:43], v20 offset:16896
ds_read_b64_tr_b16 a[44:45], v21 offset:16384
v_mfma_f32_32x32x16_bf16 v[72:87], a[88:91], v[252:255], v[72:87]
buffer_load_dwordx4 v[244:247], v176, s[32:35], s12 offen offset:2048 sc1
ds_read_b64_tr_b16 a[46:47], v21 offset:16896
s_waitcnt vmcnt(9)
v_mfma_f32_32x32x16_bf16 v[88:103], a[100:103], v[208:211], v[88:103]
ds_read_b64_tr_b16 a[48:49], v20 offset:24576
ds_read_b64_tr_b16 a[50:51], v20 offset:25088
buffer_load_dwordx4 v[248:251], v176, s[32:35], s13 offen offset:0 sc1
ds_read_b64_tr_b16 a[52:53], v21 offset:24576
v_mfma_f32_32x32x16_bf16 v[72:87], a[96:99], v[208:211], v[72:87]
ds_read_b64_tr_b16 a[54:55], v21 offset:25088
ds_read_b64_tr_b16 a[56:57], v22 offset:0
ds_read_b64_tr_b16 a[58:59], v22 offset:512
buffer_load_dwordx4 v[252:255], v176, s[32:35], s13 offen offset:2048 sc1
v_mfma_f32_32x32x16_bf16 v[88:103], a[108:111], v[212:215], v[88:103]
ds_read_b64_tr_b16 a[60:61], v23 offset:0
ds_read_b64_tr_b16 a[62:63], v23 offset:512
v_mfma_f32_32x32x16_bf16 v[72:87], a[104:107], v[212:215], v[72:87]
s_waitcnt vmcnt(9)
v_mfma_f32_32x32x16_bf16 v[88:103], a[116:119], v[216:219], v[88:103]
ds_read_b64_tr_b16 a[64:65], v22 offset:8192
ds_read_b64_tr_b16 a[66:67], v22 offset:8704
buffer_load_dwordx4 v[208:211], v176, s[32:35], s14 offen offset:0 sc1
ds_read_b64_tr_b16 a[68:69], v23 offset:8192
v_mfma_f32_32x32x16_bf16 v[72:87], a[112:115], v[216:219], v[72:87]
ds_read_b64_tr_b16 a[70:71], v23 offset:8704
ds_read_b64_tr_b16 a[72:73], v22 offset:49152
ds_read_b64_tr_b16 a[74:75], v22 offset:49664
buffer_load_dwordx4 v[212:215], v176, s[32:35], s14 offen offset:2048 sc1
v_mfma_f32_32x32x16_bf16 v[88:103], a[124:127], v[220:223], v[88:103]
ds_read_b64_tr_b16 a[76:77], v23 offset:49152
ds_read_b64_tr_b16 a[78:79], v23 offset:49664
v_mfma_f32_32x32x16_bf16 v[72:87], a[120:123], v[220:223], v[72:87]
s_waitcnt vmcnt(9)
v_mfma_f32_32x32x16_bf16 v[88:103], a[132:135], v[224:227], v[88:103]
ds_read_b64_tr_b16 a[192:193], v22 offset:57344
ds_read_b64_tr_b16 a[194:195], v22 offset:57856
buffer_load_dwordx4 v[216:219], v176, s[32:35], s15 offen offset:0 sc1
ds_read_b64_tr_b16 a[196:197], v23 offset:57344
v_mfma_f32_32x32x16_bf16 v[72:87], a[128:131], v[224:227], v[72:87]
ds_read_b64_tr_b16 a[198:199], v23 offset:57856
ds_read_b64_tr_b16 a[200:201], v24 offset:0
ds_read_b64_tr_b16 a[202:203], v24 offset:512
buffer_load_dwordx4 v[220:223], v176, s[32:35], s15 offen offset:2048 sc1
v_mfma_f32_32x32x16_bf16 v[88:103], a[140:143], v[228:231], v[88:103]
ds_read_b64_tr_b16 a[204:205], v25 offset:0
ds_read_b64_tr_b16 a[206:207], v25 offset:512
v_mfma_f32_32x32x16_bf16 v[72:87], a[136:139], v[228:231], v[72:87]
s_waitcnt vmcnt(9)
v_mfma_f32_32x32x16_bf16 v[88:103], a[148:151], v[232:235], v[88:103]
buffer_load_dwordx4 v[224:227], v177, s[32:35], s12 offen offset:0 sc1
buffer_load_dwordx4 v[228:231], v177, s[32:35], s12 offen offset:2048 sc1
buffer_load_dwordx4 v[136:139], v171, s[32:35], 0 offen offset:0 sc1
v_mfma_f32_32x32x16_bf16 v[88:103], a[156:159], v[236:239], v[88:103]
buffer_load_dwordx4 v[140:143], v171, s[32:35], 0 offen offset:1024 sc1
v_mfma_f32_32x32x16_bf16 v[72:87], a[144:147], v[232:235], v[72:87]
buffer_load_dwordx4 v[144:147], v171, s[32:35], 0 offen offset:2048 sc1
v_mfma_f32_32x32x16_bf16 v[72:87], a[152:155], v[236:239], v[72:87]
s_waitcnt vmcnt(11)
s_waitcnt lgkmcnt(0)
v_mfma_f32_32x32x16_bf16 v[120:135], a[164:167], v[240:243], 0
buffer_load_dwordx4 v[232:235], v177, s[32:35], s13 offen offset:0 sc1
v_mfma_f32_32x32x16_bf16 v[104:119], a[160:163], v[240:243], 0
s_nop 2
ds_write_b128 v172, v[88:91] offset:32768
buffer_load_dwordx4 v[236:239], v177, s[32:35], s13 offen offset:2048 sc1
v_mfma_f32_32x32x16_bf16 v[120:135], a[172:175], v[244:247], v[120:135]
v_mfma_f32_32x32x16_bf16 v[104:119], a[168:171], v[244:247], v[104:119]
ds_write_b128 v172, v[92:95] offset:33792
s_waitcnt vmcnt(11)
v_mfma_f32_32x32x16_bf16 v[120:135], a[180:183], v[248:251], v[120:135]
buffer_load_dwordx4 v[240:243], v177, s[32:35], s14 offen offset:0 sc1
v_mfma_f32_32x32x16_bf16 v[104:119], a[176:179], v[248:251], v[104:119]
ds_write_b128 v172, v[96:99] offset:40960
buffer_load_dwordx4 v[244:247], v177, s[32:35], s14 offen offset:2048 sc1
v_mfma_f32_32x32x16_bf16 v[120:135], a[188:191], v[252:255], v[120:135]
v_mfma_f32_32x32x16_bf16 v[104:119], a[184:187], v[252:255], v[104:119]
ds_write_b128 v172, v[100:103] offset:41984
s_waitcnt vmcnt(11)
s_waitcnt lgkmcnt(0)
s_barrier
v_mfma_f32_32x32x16_bf16 v[120:135], a[4:7], v[208:211], v[120:135]
ds_read_b128 v[88:91], v173 offset:32768
buffer_load_dwordx4 v[248:251], v177, s[32:35], s15 offen offset:0 sc1
ds_read_b128 v[92:95], v173 offset:33792
ds_read_b128 v[96:99], v173 offset:40960
v_mfma_f32_32x32x16_bf16 v[104:119], a[0:3], v[208:211], v[104:119]
ds_read_b128 v[100:103], v173 offset:41984
buffer_load_dwordx4 v[252:255], v177, s[32:35], s15 offen offset:2048 sc1
v_mfma_f32_32x32x16_bf16 v[120:135], a[12:15], v[212:215], v[120:135]
v_mul_f32 v157, 0xbfb8aa3b, v156
v_mfma_f32_32x32x16_bf16 v[104:119], a[8:11], v[212:215], v[104:119]
s_waitcnt vmcnt(11)
v_mfma_f32_32x32x16_bf16 v[120:135], a[20:23], v[216:219], v[120:135]
s_waitcnt lgkmcnt(0)
v_add_f32 v72, v72, v88
v_add_f32 v73, v73, v89
v_add_f32 v74, v74, v90
v_add_f32 v75, v75, v91
v_add_f32 v76, v76, v92
v_add_f32 v77, v77, v93
v_mfma_f32_32x32x16_bf16 v[104:119], a[16:19], v[216:219], v[104:119]
v_add_f32 v78, v78, v94
v_add_f32 v79, v79, v95
v_add_f32 v80, v80, v96
v_add_f32 v81, v81, v97
v_add_f32 v82, v82, v98
v_add_f32 v83, v83, v99
v_mfma_f32_32x32x16_bf16 v[120:135], a[28:31], v[220:223], v[120:135]
v_add_f32 v84, v84, v100
v_add_f32 v85, v85, v101
v_add_f32 v86, v86, v102
v_add_f32 v87, v87, v103
v_mfma_f32_32x32x16_bf16 v[104:119], a[24:27], v[220:223], v[104:119]
s_waitcnt vmcnt(9)
v_mfma_f32_32x32x16_bf16 v[120:135], a[36:39], v[224:227], v[120:135]
s_waitcnt vmcnt(6)
v_xor_b32 v139, s86, v139
v_xor_b32 v143, s86, v143
v_xor_b32 v147, s86, v147
v_mfma_f32_32x32x16_bf16 v[104:119], a[32:35], v[224:227], v[104:119]
v_or3_b32 v139, v139, v143, v147
v_cmp_ne_u32 vcc, 0, v139
v_mfma_f32_32x32x16_bf16 v[120:135], a[44:47], v[228:231], v[120:135]
s_cmp_lg_u64 vcc, 0
s_cbranch_scc1 XG_SF
XG_XF:
v_mfma_f32_32x32x16_bf16 v[104:119], a[40:43], v[228:231], v[104:119]
s_waitcnt vmcnt(4)
v_mfma_f32_32x32x16_bf16 v[120:135], a[52:55], v[232:235], v[120:135]
v_lshlrev_b32 v40, 16, v136
v_and_b32 v41, 0xffff0000, v136
v_lshlrev_b32 v42, 16, v137
v_and_b32 v43, 0xffff0000, v137
v_add_f32 v72, v72, v40
v_add_f32 v73, v73, v41
v_mfma_f32_32x32x16_bf16 v[104:119], a[48:51], v[232:235], v[104:119]
v_add_f32 v74, v74, v42
v_add_f32 v75, v75, v43
v_mul_f32 v40, v72, v157
v_mul_f32 v41, v73, v157
v_mul_f32 v42, v74, v157
v_mul_f32 v43, v75, v157
v_mfma_f32_32x32x16_bf16 v[120:135], a[60:63], v[236:239], v[120:135]
v_exp_f32 v40, v40
v_exp_f32 v41, v41
v_exp_f32 v42, v42
v_mfma_f32_32x32x16_bf16 v[104:119], a[56:59], v[236:239], v[104:119]
v_exp_f32 v43, v43
v_mul_f32 v72, v72, v156
v_mul_f32 v73, v73, v156
v_mul_f32 v74, v74, v156
v_mul_f32 v75, v75, v156
v_add_f32 v40, 1.0, v40
s_waitcnt vmcnt(2)
v_mfma_f32_32x32x16_bf16 v[120:135], a[68:71], v[240:243], v[120:135]
v_add_f32 v41, 1.0, v41
v_add_f32 v42, 1.0, v42
v_add_f32 v43, 1.0, v43
v_rcp_f32 v40, v40
v_mfma_f32_32x32x16_bf16 v[104:119], a[64:67], v[240:243], v[104:119]
v_rcp_f32 v41, v41
v_rcp_f32 v42, v42
v_rcp_f32 v43, v43
v_mfma_f32_32x32x16_bf16 v[120:135], a[76:79], v[244:247], v[120:135]
v_mul_f32 v72, v72, v40
v_mul_f32 v73, v73, v41
v_mul_f32 v74, v74, v42
v_mul_f32 v75, v75, v43
v_lshlrev_b32 v44, 16, v138
v_and_b32 v45, 0xffff0000, v138
v_mfma_f32_32x32x16_bf16 v[104:119], a[72:75], v[244:247], v[104:119]
v_lshlrev_b32 v46, 16, v140
v_and_b32 v47, 0xffff0000, v140
v_add_f32 v76, v76, v44
v_add_f32 v77, v77, v45
v_add_f32 v78, v78, v46
v_add_f32 v79, v79, v47
v_mul_f32 v44, v76, v157
v_mul_f32 v45, v77, v157
s_waitcnt vmcnt(0)
v_mfma_f32_32x32x16_bf16 v[120:135], a[196:199], v[248:251], v[120:135]
v_mul_f32 v46, v78, v157
v_mul_f32 v47, v79, v157
v_exp_f32 v44, v44
v_exp_f32 v45, v45
v_mfma_f32_32x32x16_bf16 v[120:135], a[204:207], v[252:255], v[120:135]
v_exp_f32 v46, v46
v_exp_f32 v47, v47
v_mul_f32 v76, v76, v156
v_mul_f32 v77, v77, v156
v_mfma_f32_32x32x16_bf16 v[104:119], a[192:195], v[248:251], v[104:119]
v_mul_f32 v78, v78, v156
v_mul_f32 v79, v79, v156
v_add_f32 v44, 1.0, v44
v_add_f32 v45, 1.0, v45
v_add_f32 v46, 1.0, v46
v_add_f32 v47, 1.0, v47
v_mfma_f32_32x32x16_bf16 v[104:119], a[200:203], v[252:255], v[104:119]
v_rcp_f32 v44, v44
v_rcp_f32 v45, v45
v_rcp_f32 v46, v46
v_rcp_f32 v47, v47
v_mul_f32 v76, v76, v44
v_mul_f32 v77, v77, v45
v_mul_f32 v78, v78, v46
v_mul_f32 v79, v79, v47
v_dot2c_f32_bf16 v80, s70, v141
ds_write_b128 v172, v[120:123] offset:49152
v_dot2c_f32_bf16 v81, s71, v141
v_dot2c_f32_bf16 v82, s70, v142
v_dot2c_f32_bf16 v83, s71, v142
ds_write_b128 v172, v[124:127] offset:50176
v_dot2c_f32_bf16 v84, s70, v144
v_dot2c_f32_bf16 v85, s71, v144
v_dot2c_f32_bf16 v86, s70, v145
v_dot2c_f32_bf16 v87, s71, v145
ds_write_b128 v172, v[128:131] offset:57344
v_pk_mul_f32 v[48:49], v[80:81], v[156:157] op_sel:[0,1] op_sel_hi:[1,1]
v_pk_mul_f32 v[50:51], v[82:83], v[156:157] op_sel:[0,1] op_sel_hi:[1,1]
v_exp_f32 v48, v48
ds_write_b128 v172, v[132:135] offset:58368
v_exp_f32 v49, v49
v_exp_f32 v50, v50
v_exp_f32 v51, v51
s_waitcnt lgkmcnt(0)
s_barrier
ds_read_b128 v[120:123], v173 offset:49152
ds_read_b128 v[124:127], v173 offset:50176
ds_read_b128 v[128:131], v173 offset:57344
ds_read_b128 v[132:135], v173 offset:58368
v_pk_mul_f32 v[80:81], v[80:81], v[156:157] op_sel_hi:[1,0]
v_pk_mul_f32 v[82:83], v[82:83], v[156:157] op_sel_hi:[1,0]
v_pk_add_f32 v[48:49], v[48:49], 1.0 op_sel_hi:[1,0]
v_pk_add_f32 v[50:51], v[50:51], 1.0 op_sel_hi:[1,0]
v_rcp_f32 v48, v48
v_rcp_f32 v49, v49
v_rcp_f32 v50, v50
v_rcp_f32 v51, v51
v_pk_mul_f32 v[80:81], v[80:81], v[48:49]
v_pk_mul_f32 v[82:83], v[82:83], v[50:51]
v_pk_mul_f32 v[52:53], v[84:85], v[156:157] op_sel:[0,1] op_sel_hi:[1,1]
v_pk_mul_f32 v[54:55], v[86:87], v[156:157] op_sel:[0,1] op_sel_hi:[1,1]
v_exp_f32 v52, v52
v_exp_f32 v53, v53
v_exp_f32 v54, v54
v_exp_f32 v55, v55
v_pk_mul_f32 v[84:85], v[84:85], v[156:157] op_sel_hi:[1,0]
v_pk_mul_f32 v[86:87], v[86:87], v[156:157] op_sel_hi:[1,0]
v_pk_add_f32 v[52:53], v[52:53], 1.0 op_sel_hi:[1,0]
v_pk_add_f32 v[54:55], v[54:55], 1.0 op_sel_hi:[1,0]
v_rcp_f32 v52, v52
v_rcp_f32 v53, v53
v_rcp_f32 v54, v54
v_rcp_f32 v55, v55
v_pk_mul_f32 v[84:85], v[84:85], v[52:53]
v_pk_mul_f32 v[86:87], v[86:87], v[54:55]
s_waitcnt lgkmcnt(3)
v_pk_add_f32 v[104:105], v[104:105], v[120:121]
v_pk_add_f32 v[106:107], v[106:107], v[122:123]
v_pk_fma_f32 v[104:105], v[104:105], v[72:73], v[56:57]
v_pk_fma_f32 v[106:107], v[106:107], v[74:75], v[58:59]
v_cvt_pk_bf16_f32 v160, v104, v105
v_cvt_pk_bf16_f32 v161, v106, v107
s_waitcnt lgkmcnt(2)
s_nop 0
v_pk_add_f32 v[108:109], v[108:109], v[124:125]
v_pk_add_f32 v[110:111], v[110:111], v[126:127]
v_pk_fma_f32 v[108:109], v[108:109], v[76:77], v[60:61]
v_pk_fma_f32 v[110:111], v[110:111], v[78:79], v[62:63]
v_cvt_pk_bf16_f32 v162, v108, v109
v_cvt_pk_bf16_f32 v163, v110, v111
s_nop 0
v_permlane32_swap_b32 v160, v162
v_permlane32_swap_b32 v161, v163
buffer_store_dwordx4 v[160:163], v158, s[28:31], 0 offen offset:0
s_waitcnt lgkmcnt(1)
v_pk_add_f32 v[112:113], v[112:113], v[128:129]
v_pk_add_f32 v[114:115], v[114:115], v[130:131]
v_pk_fma_f32 v[112:113], v[112:113], v[80:81], v[64:65]
v_pk_fma_f32 v[114:115], v[114:115], v[82:83], v[66:67]
v_cvt_pk_bf16_f32 v164, v112, v113
v_cvt_pk_bf16_f32 v165, v114, v115
s_waitcnt lgkmcnt(0)
s_nop 0
v_pk_add_f32 v[116:117], v[116:117], v[132:133]
PADF4:
s_cbranch_execz BACK_F
s_nop 0
v_pk_add_f32 v[118:119], v[118:119], v[134:135]
v_pk_fma_f32 v[116:117], v[116:117], v[84:85], v[68:69]
v_pk_fma_f32 v[118:119], v[118:119], v[86:87], v[70:71]
v_cvt_pk_bf16_f32 v166, v116, v117
v_cvt_pk_bf16_f32 v167, v118, v119
s_nop 0
v_permlane32_swap_b32 v164, v166
v_permlane32_swap_b32 v165, v167
buffer_store_dwordx4 v[164:167], v158, s[28:31], 0 offen offset:32
s_endpgm
END_F:
.p2align 12
R_QKV:
s_mov_b32 s32, s20
s_mov_b32 s33, s21
s_mov_b32 s34, 13205504
s_mov_b32 s35, 0x20000
v_and_b32 v200, 15, v0
v_lshrrev_b32 v201, 4, v0
v_mov_b32 v204, 0x3f803f80
v_mov_b32 v208, 0
v_mov_b32 v205, 0x3f803f80
v_mov_b32 v209, 0
v_mov_b32 v206, 0x3f803f80
v_mov_b32 v210, 0
v_mov_b32 v207, 0x3f803f80
v_mov_b32 v211, 0
v_and_b32 v3, 7, v0
v_and_b32 v4, 2, v0
v_bfe_u32 v5, v0, 3, 1
v_lshl_add_u32 v4, v5, 2, v4
v_add_u32 v4, 7, v4
v_and_b32 v4, 7, v4
v_lshlrev_b32 v4, 4, v4
v_lshl_add_u32 v3, v3, 7, v4
v_lshrrev_b32 v4, 3, v0
v_mul_u32_u24 v4, 3072, v4
s_mul_i32 s63, s72, 24576
s_add_u32 s63, s63, 55296
v_add3_u32 v3, v3, v4, s63
ds_write_b128 v3, v[204:207] offset:1024
s_min_u32 s63, s3, 2
s_mul_i32 s63, s63, 18432
v_lshlrev_b32 v4, 4, v0
v_add_u32 v4, s63, v4
ds_write_b128 v4, v[204:207] offset:0
v_lshrrev_b32 v3, 1, v200
v_xor_b32 v3, v201, v3
v_lshlrev_b32 v3, 4, v3
v_lshl_add_u32 v3, v200, 7, v3
s_lshl_b32 s63, s73, 13
v_add_u32 v4, s63, v3
v_add_u32 v44, 2048, v4
v_xor_b32 v45, 64, v44
v_cmp_gt_u32 vcc, 8, v200
s_nop 1
v_cndmask_b32 v46, v4, v3, vcc
v_xor_b32 v47, 64, v46
s_nop 0
v_bfe_u32 v3, v0, 2, 2
v_mul_u32_u24 v4, 3072, v201
v_lshl_add_u32 v3, v3, 7, v4
v_add_u32 v3, 55296, v3
v_bfe_u32 v4, v0, 3, 2
v_lshlrev_b32 v4, 5, v4
v_and_b32 v5, 3, v0
s_mul_i32 s63, s72, 56
v_lshl_add_u32 v6, v5, 3, s63
v_add_u32 v7, v6, v4
v_and_b32 v7, 127, v7
v_add_u32 v48, v3, v7
s_lshl_b32 s63, s72, 3
s_sub_u32 s63, 120, s63
v_mov_b32 v7, s63
v_add_u32 v6, 32, v6
v_cmp_eq_u32 vcc, 3, v5
s_nop 1
v_cndmask_b32 v6, v6, v7, vcc
v_add_u32 v7, v6, v4
v_and_b32 v7, 127, v7
v_add_u32 v49, v3, v7
v_lshlrev_b32 v3, 2, v201
v_sub_u32 v3, v200, v3
v_mov_b32 v4, 0xff800000
s_or_b32 s63, s61, s73
s_cmp_eq_u32 s63, 0
s_cselect_b32 s63, 0xff800000, 0
v_subrev_u32 v5, 0, v3
v_cmp_gt_i32 vcc, -8, v5
s_nop 1
v_cndmask_b32 v184, v4, v208, vcc
v_cmp_gt_u32 vcc, 8, v5
s_nop 1
v_cndmask_b32 v188, v4, v208, vcc
v_or_b32 v192, s63, v184
v_subrev_u32 v5, 1, v3
v_cmp_gt_i32 vcc, -8, v5
s_nop 1
v_cndmask_b32 v185, v4, v208, vcc
v_cmp_gt_u32 vcc, 8, v5
s_nop 1
v_cndmask_b32 v189, v4, v208, vcc
v_or_b32 v193, s63, v185
v_subrev_u32 v5, 2, v3
v_cmp_gt_i32 vcc, -8, v5
s_nop 1
v_cndmask_b32 v186, v4, v208, vcc
v_cmp_gt_u32 vcc, 8, v5
s_nop 1
v_cndmask_b32 v190, v4, v208, vcc
v_or_b32 v194, s63, v186
v_subrev_u32 v5, 3, v3
v_cmp_gt_i32 vcc, -8, v5
s_nop 1
v_cndmask_b32 v187, v4, v208, vcc
v_cmp_gt_u32 vcc, 8, v5
s_nop 1
v_cndmask_b32 v191, v4, v208, vcc
v_or_b32 v195, s63, v187
v_ashrrev_i32 v5, 31, v184
v_ashrrev_i32 v6, 31, v185
v_and_b32 v5, 0xffff, v5
v_and_b32 v6, 0xffff0000, v6
v_or_b32 v5, v5, v6
v_not_b32 v196, v5
v_ashrrev_i32 v5, 31, v186
v_ashrrev_i32 v6, 31, v187
v_and_b32 v5, 0xffff, v5
v_and_b32 v6, 0xffff0000, v6
v_or_b32 v5, v5, v6
v_not_b32 v197, v5
v_ashrrev_i32 v5, 31, v188
v_ashrrev_i32 v6, 31, v189
v_and_b32 v5, 0xffff, v5
v_and_b32 v6, 0xffff0000, v6
v_or_b32 v5, v5, v6
v_not_b32 v198, v5
v_ashrrev_i32 v5, 31, v190
v_ashrrev_i32 v6, 31, v191
v_and_b32 v5, 0xffff, v5
v_and_b32 v6, 0xffff0000, v6
v_or_b32 v5, v5, v6
v_not_b32 v199, v5
v_lshlrev_b32 v220, 2, v200
v_bfe_u32 v221, v0, 2, 2
v_lshl_add_u32 v221, v221, 6, v220
v_add_u32 v220, 192, v220
v_and_b32 v5, 1, v0
v_cmp_eq_u32 s[56:57], 1, v5
v_and_b32 v5, 2, v0
v_cmp_eq_u32 s[58:59], 2, v5
s_lshl_b32 s64, s3, 11
v_mul_u32_u24 v222, 80, v200
v_lshl_add_u32 v222, v201, 4, v222
v_add_u32 v222, s64, v222
v_lshrrev_b32 v223, 2, v0
v_mul_u32_u24 v223, 80, v223
v_and_b32 v7, 3, v0
v_lshl_add_u32 v223, v7, 4, v223
v_add_u32 v223, s64, v223
v_add_u32 v226, 65536, v222
v_add_u32 v227, 65536, v223
v_lshlrev_b32 v225, 4, v0
s_lshl_b32 s64, s60, 3
s_add_u32 s64, s64, s61
s_lshl_b32 s64, s64, 1
s_add_u32 s64, s64, s73
s_lshl_b32 s63, s62, 1
s_add_u32 s63, s63, s72
s_lshl_b32 s63, s63, 12
s_mul_i32 s70, s64, 294912
s_add_u32 s70, s70, s63
s_lshl_b32 s64, s64, 8
s_lshl_b32 s63, s62, 13
s_add_u32 s64, s64, s63
s_add_u32 s64, s64, 9437184
s_cmp_eq_u32 s72, 0
s_cselect_b32 s64, s64, 0x80000000
v_lshl_add_u32 v224, v0, 2, s64
s_lshl_b32 s63, s60, 3
s_add_u32 s63, s63, s61
s_lshl_b32 s63, s63, 1
s_add_u32 s63, s63, s73
s_lshl_b32 s63, s63, 13
s_add_u32 s63, s63, 9797888
s_or_b32 s64, s61, s73
s_cmp_eq_u32 s64, 0
s_cselect_b32 s64, 0, -4096
v_lshlrev_b32 v3, 12, v201
v_mov_b32 v4, s64
v_cmp_lt_u32 vcc, 31, v0
s_nop 1
v_cndmask_b32 v3, v3, v4, vcc
v_add_u32 v3, s63, v3
v_lshl_add_u32 v221, v200, 4, v3
s_bfe_u32 s63, s2, 0x20001
s_lshl_b32 s63, s63, 2
s_bfe_u32 s82, s2, 0x20003
s_add_u32 s63, s63, s82
s_lshl_b32 s63, s63, 1
s_and_b32 s65, s2, 1
s_add_u32 s74, s63, s65
s_lshr_b32 s75, s2, 5
s_lshl_b32 s63, s75, 2
s_lshr_b32 s63, 808464432, s63
s_and_b32 s63, s63, 15
s_lshl_b32 s64, s82, 1
s_add_u32 s63, s63, s64
s_sub_u32 s64, s63, 7
s_cmp_ge_u32 s63, 7
s_cselect_b32 s83, s64, s63
s_lshl_b32 s65, s65, 2
s_add_u32 s65, s65, s3
s_mul_i32 s78, s65, 200704
s_add_u32 s79, s78, 200704
s_mul_i32 s64, s83, 28672
s_add_u32 s76, s78, s64
s_mul_i32 s80, s3, 100352
s_add_u32 s81, s80, 100352
s_mul_i32 s64, s82, 25088
s_add_u32 s77, s80, s64
s_xor_b32 s63, s74, 1
s_mul_i32 s63, s63, 144
s_add_u32 s63, s63, 32
s_lshl_b32 s63, s63, 1
s_add_u32 s63, s63, s72
s_lshl_b32 s63, s63, 10
v_lshl_add_u32 v3, v0, 4, s63
s_mul_i32 s64, s65, 28672
v_add_u32 v10, s64, v3
s_xor_b32 s64, s65, 1
s_mul_i32 s64, s64, 28672
v_add_u32 v11, s64, v3
v_lshrrev_b32 v3, 3, v0
v_mul_u32_u24 v3, 896, v3
v_bfe_u32 v4, v0, 4, 1
v_lshlrev_b32 v4, 2, v4
v_and_b32 v5, 7, v0
v_xor_b32 v4, v4, v5
s_lshl_b32 s64, s75, 7
v_lshl_add_u32 v3, v4, 4, v3
v_add_u32 v12, s64, v3
v_add_u32 v13, 6144, v12
s_lshl_b32 s85, s3, 11
s_cmp_lt_u32 s2, 224
s_cselect_b32 s63, 1605632, 0
s_cselect_b32 s64, 401408, 0
s_mov_b32 s36, s14
s_mov_b32 s37, s15
s_mov_b32 s38, s63
s_mov_b32 s39, 0x20000
s_mov_b32 s40, s8
s_mov_b32 s41, s9
s_mov_b32 s42, s64
s_mov_b32 s43, 0x20000
s_lshl_b32 s64, s73, 6
v_bfe_u32 v3, v0, 2, 2
v_lshrrev_b32 v4, 5, v0
v_lshl_add_u32 v3, v4, 3, v3
v_lshlrev_b32 v3, 7, v3
v_bfe_u32 v4, v0, 3, 1
v_lshl_add_u32 v3, v4, 6, v3
v_bfe_u32 v4, v0, 4, 1
v_lshl_add_u32 v3, v4, 5, v3
v_and_b32 v4, 3, v0
v_lshl_add_u32 v3, v4, 3, v3
v_xor_b32 v3, s64, v3
v_add_u32 v14, s85, v3
v_xor_b32 v15, 64, v14
v_add_u32 v16, 65536, v14
v_add_u32 v17, 65536, v15
v_add_u32 v18, 131072, v14
v_add_u32 v19, 131072, v15
v_xor_b32 v20, 2048, v14
v_xor_b32 v21, 2048, v15
v_xor_b32 v22, 2048, v16
v_xor_b32 v23, 2048, v17
v_xor_b32 v24, 2048, v18
v_xor_b32 v25, 2048, v19
s_and_b32 s63, s74, 15
s_mul_i32 s63, s63, 114688
s_lshr_b32 s64, s74, 4
s_mul_i32 s64, s64, 896
s_add_u32 s63, s63, s64
s_lshl_b32 s64, s75, 7
s_add_u32 s84, s63, s64
s_mul_i32 s63, s3, 28672
s_add_u32 s63, s63, s84
v_lshrrev_b32 v3, 3, v0
v_and_b32 v4, 7, v0
v_xor_b32 v4, v3, v4
v_mul_u32_u24 v3, 1792, v3
v_lshl_add_u32 v3, v4, 4, v3
v_add_u32 v26, s63, v3
s_lshr_b32 s63, s74, 4
s_lshl_b32 s63, s63, 2
s_bfe_u32 s64, s74, 0x30001
s_lshl_b32 s64, s64, 3
s_add_u32 s63, s63, s64
s_lshl_b32 s63, s63, 7
s_add_u32 s63, s63, 9502720
v_and_b32 v3, 1, v0
v_lshl_add_u32 v27, v3, 13, s63
s_lshr_b32 s65, s65, 1
s_lshl_b32 s65, s65, 7
s_lshl_b32 s64, s3, 7
s_add_u32 s64, s64, 16384
v_mov_b32 v3, s65
v_mov_b32 v4, s64
v_cmp_lt_u32 vcc, 1, v0
s_nop 1
v_cndmask_b32 v3, v3, v4, vcc
v_xor_b32 v4, 128, v4
v_cmp_lt_u32 vcc, 3, v0
s_nop 1
v_cndmask_b32 v3, v3, v4, vcc
v_add_u32 v27, v27, v3
v_mov_b32 v3, 0x80000000
v_cmp_lt_u32 vcc, 5, v0
s_nop 1
v_cndmask_b32 v27, v27, v3, vcc
s_mov_b32 s44, s18
s_mov_b32 s45, s19
s_mov_b32 s46, 256
s_mov_b32 s47, 0x20000
v_mov_b32 v28, 0
s_sub_u32 s63, s2, 224
s_lshl_b32 s63, s63, 2
s_add_u32 s63, s63, s3
s_sub_u32 s64, s63, 98
s_cmp_lt_u32 s63, 98
s_cselect_b32 s63, s63, s64
s_cselect_b32 s48, s14, s8
s_cselect_b32 s49, s15, s9
s_mov_b32 s50, 401408
s_cselect_b32 s50, 1605632, s50
s_mov_b32 s51, 0x20000
s_cmp_lt_u32 s2, 224
s_cselect_b32 s50, 0, s50
s_cselect_b32 s63, 0, s63
s_mul_i32 s63, s63, 16384
v_lshl_add_u32 v30, v0, 8, s63
s_add_u32 s6, s66, 128
s_cmp_eq_u32 s6, 896
s_cselect_b32 s6, 0, s6
s_mul_i32 s12, s6, 1344
s_add_u32 s7, s6, 128
s_cmp_eq_u32 s7, 896
s_cselect_b32 s7, 0, s7
s_mul_i32 s13, s7, 1344
s_add_u32 s8, s7, 128
s_cmp_eq_u32 s8, 896
s_cselect_b32 s8, 0, s8
s_mul_i32 s14, s8, 1344
s_add_u32 s9, s8, 128
s_cmp_eq_u32 s9, 896
s_cselect_b32 s9, 0, s9
s_mul_i32 s15, s9, 1344
s_add_u32 s10, s9, 128
s_cmp_eq_u32 s10, 896
s_cselect_b32 s10, 0, s10
s_mul_i32 s18, s10, 1344
s_add_u32 s11, s10, 128
s_cmp_eq_u32 s11, 896
s_cselect_b32 s11, 0, s11
s_mul_i32 s19, s11, 1344
s_add_u32 m0, s68, 67584
s_nop 0
buffer_load_dwordx4 v41, s[28:31], s67 offen offset:0 lds
s_mov_b64 exec, s[52:53]
buffer_load_dwordx4 v42, s[28:31], s67 offen offset:1024 lds
s_mov_b64 exec, -1
buffer_load_dwordx4 v43, s[28:31], s67 offen offset:2048 lds
WARM_Q:
s_mov_b64 exec, 0
s_cmp_eq_u32 s3, 0
s_cbranch_scc1 PADQ1
s_cmp_eq_u32 s3, 1
s_cbranch_scc1 PADQ2
s_cmp_eq_u32 s3, 2
s_cbranch_scc1 PADQ3
s_branch PADQ4
BACK_Q:
s_mov_b64 exec, -1
s_add_u32 m0, s69, 20480
s_nop 0
buffer_load_dwordx4 v33, s[24:27], s6 offen offset:0 lds
buffer_load_dwordx4 v34, s[24:27], s6 offen offset:1024 lds
buffer_load_dwordx4 v35, s[24:27], s6 offen offset:2048 lds
buffer_load_dwordx4 v36, s[24:27], s6 offen offset:3072 lds
s_mov_b32 m0, 19456
s_mov_b64 exec, s[54:55]
buffer_load_dwordx4 v37, s[24:27], s6 offen lds
s_mov_b64 exec, -1
s_add_u32 m0, s68, 79872
s_nop 0
buffer_load_dwordx4 v38, s[28:31], s12 offen offset:0 lds
s_mov_b64 exec, s[52:53]
buffer_load_dwordx4 v39, s[28:31], s12 offen offset:1024 lds
s_mov_b64 exec, -1
s_waitcnt vmcnt(10) lgkmcnt(0)
s_barrier
ds_read_b128 a[0:3], v46 offset:0
ds_read_b128 a[4:7], v44 offset:0
ds_read_b128 a[8:11], v44 offset:2048
ds_read_b128 a[12:15], v44 offset:4096
ds_read_b128 a[16:19], v44 offset:6144
ds_read_b64_tr_b16 a[28:29], v48 offset:1024
ds_read_b64_tr_b16 a[30:31], v48 offset:1536
ds_read_b64_tr_b16 a[32:33], v49 offset:1024
ds_read_b64_tr_b16 a[34:35], v49 offset:1536
ds_read_b64_tr_b16 a[36:37], v48 offset:2048
ds_read_b64_tr_b16 a[38:39], v48 offset:2560
ds_read_b64_tr_b16 a[40:41], v49 offset:2048
ds_read_b64_tr_b16 a[42:43], v49 offset:2560
ds_read_b64_tr_b16 a[20:21], v48 offset:0
ds_read_b64_tr_b16 a[22:23], v48 offset:512
ds_read_b64_tr_b16 a[24:25], v49 offset:0
ds_read_b64_tr_b16 a[26:27], v49 offset:512
s_waitcnt vmcnt(7) lgkmcnt(0)
s_barrier
v_mfma_f32_16x16x32_bf16 v[112:115], a[32:35], a[0:3], 0
ds_read_b128 a[44:47], v47 offset:0
s_add_u32 m0, s68, 79872
v_mfma_f32_16x16x32_bf16 v[116:119], a[32:35], a[4:7], 0
ds_read_b128 a[48:51], v45 offset:0
v_mfma_f32_16x16x32_bf16 v[120:123], a[32:35], a[8:11], 0
ds_read_b128 a[52:55], v45 offset:2048
v_mfma_f32_16x16x32_bf16 v[124:127], a[32:35], a[12:15], 0
buffer_load_dwordx4 v40, s[28:31], s12 offen offset:2048 lds
ds_read_b128 a[56:59], v45 offset:4096
v_mfma_f32_16x16x32_bf16 v[128:131], a[32:35], a[16:19], 0
v_mfma_f32_16x16x32_bf16 v[92:95], a[28:31], a[0:3], 0
ds_read_b128 a[60:63], v45 offset:6144
v_mfma_f32_16x16x32_bf16 v[96:99], a[28:31], a[4:7], 0
s_add_u32 m0, s68, 92160
ds_read_b64_tr_b16 a[72:73], v48 offset:13312
v_mfma_f32_16x16x32_bf16 v[100:103], a[28:31], a[8:11], 0
v_mfma_f32_16x16x32_bf16 v[104:107], a[28:31], a[12:15], 0
ds_read_b64_tr_b16 a[74:75], v48 offset:13824
buffer_load_dwordx4 v41, s[28:31], s12 offen offset:0 lds
v_mfma_f32_16x16x32_bf16 v[108:111], a[28:31], a[16:19], 0
ds_read_b64_tr_b16 a[76:77], v49 offset:13312
v_mfma_f32_16x16x32_bf16 v[152:155], a[40:43], a[0:3], 0
v_mfma_f32_16x16x32_bf16 v[156:159], a[40:43], a[4:7], 0
ds_read_b64_tr_b16 a[78:79], v49 offset:13824
v_mfma_f32_16x16x32_bf16 v[160:163], a[40:43], a[8:11], 0
ds_read_b64_tr_b16 a[80:81], v48 offset:14336
v_mfma_f32_16x16x32_bf16 v[164:167], a[40:43], a[12:15], 0
ds_read_b64_tr_b16 a[82:83], v48 offset:14848
v_mfma_f32_16x16x32_bf16 v[168:171], a[40:43], a[16:19], 0
s_mov_b64 exec, s[52:53]
buffer_load_dwordx4 v42, s[28:31], s12 offen offset:1024 lds
s_mov_b64 exec, -1
v_mfma_f32_16x16x32_bf16 v[132:135], a[36:39], a[0:3], 0
buffer_load_dwordx4 v43, s[28:31], s12 offen offset:2048 lds
ds_read_b64_tr_b16 a[84:85], v49 offset:14336
v_mfma_f32_16x16x32_bf16 v[136:139], a[36:39], a[4:7], 0
ds_read_b64_tr_b16 a[86:87], v49 offset:14848
v_mfma_f32_16x16x32_bf16 v[140:143], a[36:39], a[8:11], 0
s_add_u32 m0, s69, 38912
v_mfma_f32_16x16x32_bf16 v[144:147], a[36:39], a[12:15], 0
ds_read_b64_tr_b16 a[64:65], v48 offset:12288
v_mfma_f32_16x16x32_bf16 v[148:151], a[36:39], a[16:19], 0
ds_read_b64_tr_b16 a[66:67], v48 offset:12800
v_mfma_f32_16x16x32_bf16 v[72:75], a[24:27], a[0:3], 0
buffer_load_dwordx4 v33, s[24:27], s7 offen offset:0 lds
ds_read_b64_tr_b16 a[68:69], v49 offset:12288
v_mfma_f32_16x16x32_bf16 v[76:79], a[24:27], a[4:7], 0
v_mfma_f32_16x16x32_bf16 v[80:83], a[24:27], a[8:11], 0
ds_read_b64_tr_b16 a[70:71], v49 offset:12800
v_mfma_f32_16x16x32_bf16 v[84:87], a[24:27], a[12:15], 0
buffer_load_dwordx4 v34, s[24:27], s7 offen offset:1024 lds
v_mfma_f32_16x16x32_bf16 v[88:91], a[24:27], a[16:19], 0
v_mfma_f32_16x16x32_bf16 v[52:55], a[20:23], a[0:3], 0
v_mfma_f32_16x16x32_bf16 v[56:59], a[20:23], a[4:7], 0
buffer_load_dwordx4 v35, s[24:27], s7 offen offset:2048 lds
v_mfma_f32_16x16x32_bf16 v[60:63], a[20:23], a[8:11], 0
v_mfma_f32_16x16x32_bf16 v[64:67], a[20:23], a[12:15], 0
v_mfma_f32_16x16x32_bf16 v[68:71], a[20:23], a[16:19], 0
s_waitcnt vmcnt(6) lgkmcnt(0)
s_barrier
v_mfma_f32_16x16x32_bf16 v[112:115], a[76:79], a[44:47], v[112:115]
ds_read_b128 a[0:3], v46 offset:18432
buffer_load_dword v2, v30, s[48:51], 0 offen offset:128
v_mfma_f32_16x16x32_bf16 v[116:119], a[76:79], a[48:51], v[116:119]
ds_read_b128 a[4:7], v44 offset:18432
v_mfma_f32_16x16x32_bf16 v[120:123], a[76:79], a[52:55], v[120:123]
buffer_load_dword v2, v30, s[48:51], 0 offen offset:0
ds_read_b128 a[8:11], v44 offset:20480
v_mfma_f32_16x16x32_bf16 v[124:127], a[76:79], a[56:59], v[124:127]
ds_read_b128 a[12:15], v44 offset:22528
v_mfma_f32_16x16x32_bf16 v[128:131], a[76:79], a[60:63], v[128:131]
s_add_u32 m0, s69, 38912
v_mfma_f32_16x16x32_bf16 v[92:95], a[72:75], a[44:47], v[92:95]
ds_read_b128 a[16:19], v44 offset:24576
v_mfma_f32_16x16x32_bf16 v[96:99], a[72:75], a[48:51], v[96:99]
buffer_load_dwordx4 v36, s[24:27], s7 offen offset:3072 lds
ds_read_b64_tr_b16 a[28:29], v48 offset:25600
v_mfma_f32_16x16x32_bf16 v[100:103], a[72:75], a[52:55], v[100:103]
v_mfma_f32_16x16x32_bf16 v[104:107], a[72:75], a[56:59], v[104:107]
ds_read_b64_tr_b16 a[30:31], v48 offset:26112
s_mov_b32 m0, 37888
v_mfma_f32_16x16x32_bf16 v[108:111], a[72:75], a[60:63], v[108:111]
ds_read_b64_tr_b16 a[32:33], v49 offset:25600
v_mfma_f32_16x16x32_bf16 v[152:155], a[84:87], a[44:47], v[152:155]
v_mfma_f32_16x16x32_bf16 v[156:159], a[84:87], a[48:51], v[156:159]
ds_read_b64_tr_b16 a[34:35], v49 offset:26112
v_mfma_f32_16x16x32_bf16 v[160:163], a[84:87], a[52:55], v[160:163]
ds_read_b64_tr_b16 a[36:37], v48 offset:26624
v_mfma_f32_16x16x32_bf16 v[164:167], a[84:87], a[56:59], v[164:167]
ds_read_b64_tr_b16 a[38:39], v48 offset:27136
v_mfma_f32_16x16x32_bf16 v[168:171], a[84:87], a[60:63], v[168:171]
s_mov_b64 exec, s[54:55]
buffer_load_dwordx4 v37, s[24:27], s7 offen lds
s_mov_b64 exec, -1
v_mfma_f32_16x16x32_bf16 v[132:135], a[80:83], a[44:47], v[132:135]
s_add_u32 m0, s68, 55296
ds_read_b64_tr_b16 a[40:41], v49 offset:26624
v_mfma_f32_16x16x32_bf16 v[136:139], a[80:83], a[48:51], v[136:139]
buffer_load_dwordx4 v38, s[28:31], s13 offen offset:0 lds
ds_read_b64_tr_b16 a[42:43], v49 offset:27136
v_mfma_f32_16x16x32_bf16 v[140:143], a[80:83], a[52:55], v[140:143]
v_mfma_f32_16x16x32_bf16 v[144:147], a[80:83], a[56:59], v[144:147]
ds_read_b64_tr_b16 a[20:21], v48 offset:24576
v_mfma_f32_16x16x32_bf16 v[148:151], a[80:83], a[60:63], v[148:151]
ds_read_b64_tr_b16 a[22:23], v48 offset:25088
v_mfma_f32_16x16x32_bf16 v[72:75], a[68:71], a[44:47], v[72:75]
ds_read_b64_tr_b16 a[24:25], v49 offset:24576
v_mfma_f32_16x16x32_bf16 v[76:79], a[68:71], a[48:51], v[76:79]
s_mov_b64 exec, s[52:53]
buffer_load_dwordx4 v39, s[28:31], s13 offen offset:1024 lds
s_mov_b64 exec, -1
v_mfma_f32_16x16x32_bf16 v[80:83], a[68:71], a[52:55], v[80:83]
buffer_load_dwordx4 v40, s[28:31], s13 offen offset:2048 lds
s_add_u32 m0, s68, 67584
v_mfma_f32_16x16x32_bf16 v[84:87], a[68:71], a[56:59], v[84:87]
ds_read_b64_tr_b16 a[26:27], v49 offset:25088
v_mfma_f32_16x16x32_bf16 v[88:91], a[68:71], a[60:63], v[88:91]
buffer_load_dwordx4 v41, s[28:31], s13 offen offset:0 lds
v_mfma_f32_16x16x32_bf16 v[52:55], a[64:67], a[44:47], v[52:55]
v_mfma_f32_16x16x32_bf16 v[56:59], a[64:67], a[48:51], v[56:59]
v_mfma_f32_16x16x32_bf16 v[60:63], a[64:67], a[52:55], v[60:63]
s_mov_b64 exec, s[52:53]
buffer_load_dwordx4 v42, s[28:31], s13 offen offset:1024 lds
s_mov_b64 exec, -1
v_mfma_f32_16x16x32_bf16 v[64:67], a[64:67], a[56:59], v[64:67]
v_mfma_f32_16x16x32_bf16 v[68:71], a[64:67], a[60:63], v[68:71]
s_waitcnt vmcnt(12) lgkmcnt(0)
s_barrier
v_mfma_f32_16x16x32_bf16 v[112:115], a[32:35], a[0:3], v[112:115]
ds_read_b128 a[44:47], v47 offset:18432
s_add_u32 m0, s68, 67584
v_mfma_f32_16x16x32_bf16 v[116:119], a[32:35], a[4:7], v[116:119]
ds_read_b128 a[48:51], v45 offset:18432
v_mfma_f32_16x16x32_bf16 v[120:123], a[32:35], a[8:11], v[120:123]
ds_read_b128 a[52:55], v45 offset:20480
buffer_load_dwordx4 v43, s[28:31], s13 offen offset:2048 lds
v_mfma_f32_16x16x32_bf16 v[124:127], a[32:35], a[12:15], v[124:127]
ds_read_b128 a[56:59], v45 offset:22528
v_mfma_f32_16x16x32_bf16 v[128:131], a[32:35], a[16:19], v[128:131]
v_mfma_f32_16x16x32_bf16 v[92:95], a[28:31], a[0:3], v[92:95]
ds_read_b128 a[60:63], v45 offset:24576
s_add_u32 m0, s69, 2048
v_mfma_f32_16x16x32_bf16 v[96:99], a[28:31], a[4:7], v[96:99]
ds_read_b64_tr_b16 a[72:73], v48 offset:37888
v_mfma_f32_16x16x32_bf16 v[100:103], a[28:31], a[8:11], v[100:103]
v_mfma_f32_16x16x32_bf16 v[104:107], a[28:31], a[12:15], v[104:107]
buffer_load_dwordx4 v33, s[24:27], s8 offen offset:0 lds
ds_read_b64_tr_b16 a[74:75], v48 offset:38400
v_mfma_f32_16x16x32_bf16 v[108:111], a[28:31], a[16:19], v[108:111]
ds_read_b64_tr_b16 a[76:77], v49 offset:37888
v_mfma_f32_16x16x32_bf16 v[152:155], a[40:43], a[0:3], v[152:155]
buffer_load_dwordx4 v34, s[24:27], s8 offen offset:1024 lds
v_mfma_f32_16x16x32_bf16 v[156:159], a[40:43], a[4:7], v[156:159]
ds_read_b64_tr_b16 a[78:79], v49 offset:38400
v_mfma_f32_16x16x32_bf16 v[160:163], a[40:43], a[8:11], v[160:163]
ds_read_b64_tr_b16 a[80:81], v48 offset:38912
v_mfma_f32_16x16x32_bf16 v[164:167], a[40:43], a[12:15], v[164:167]
buffer_load_dwordx4 v35, s[24:27], s8 offen offset:2048 lds
ds_read_b64_tr_b16 a[82:83], v48 offset:39424
v_mfma_f32_16x16x32_bf16 v[168:171], a[40:43], a[16:19], v[168:171]
v_mfma_f32_16x16x32_bf16 v[132:135], a[36:39], a[0:3], v[132:135]
ds_read_b64_tr_b16 a[84:85], v49 offset:38912
buffer_load_dwordx4 v36, s[24:27], s8 offen offset:3072 lds
v_mfma_f32_16x16x32_bf16 v[136:139], a[36:39], a[4:7], v[136:139]
ds_read_b64_tr_b16 a[86:87], v49 offset:39424
v_mfma_f32_16x16x32_bf16 v[140:143], a[36:39], a[8:11], v[140:143]
v_mfma_f32_16x16x32_bf16 v[144:147], a[36:39], a[12:15], v[144:147]
ds_read_b64_tr_b16 a[64:65], v48 offset:36864
s_mov_b32 m0, 1024
v_mfma_f32_16x16x32_bf16 v[148:151], a[36:39], a[16:19], v[148:151]
ds_read_b64_tr_b16 a[66:67], v48 offset:37376
v_mfma_f32_16x16x32_bf16 v[72:75], a[24:27], a[0:3], v[72:75]
ds_read_b64_tr_b16 a[68:69], v49 offset:36864
v_mfma_f32_16x16x32_bf16 v[76:79], a[24:27], a[4:7], v[76:79]
v_mfma_f32_16x16x32_bf16 v[80:83], a[24:27], a[8:11], v[80:83]
ds_read_b64_tr_b16 a[70:71], v49 offset:37376
v_mfma_f32_16x16x32_bf16 v[84:87], a[24:27], a[12:15], v[84:87]
s_mov_b64 exec, s[54:55]
buffer_load_dwordx4 v37, s[24:27], s8 offen lds
s_mov_b64 exec, -1
v_mfma_f32_16x16x32_bf16 v[88:91], a[24:27], a[16:19], v[88:91]
s_add_u32 m0, s68, 79872
v_mfma_f32_16x16x32_bf16 v[52:55], a[20:23], a[0:3], v[52:55]
v_mfma_f32_16x16x32_bf16 v[56:59], a[20:23], a[4:7], v[56:59]
buffer_load_dwordx4 v38, s[28:31], s14 offen offset:0 lds
v_mfma_f32_16x16x32_bf16 v[60:63], a[20:23], a[8:11], v[60:63]
v_mfma_f32_16x16x32_bf16 v[64:67], a[20:23], a[12:15], v[64:67]
v_mfma_f32_16x16x32_bf16 v[68:71], a[20:23], a[16:19], v[68:71]
s_waitcnt vmcnt(9) lgkmcnt(0)
s_barrier
v_mfma_f32_16x16x32_bf16 v[112:115], a[76:79], a[44:47], v[112:115]
ds_read_b128 a[0:3], v46 offset:36864
s_add_u32 m0, s68, 79872
v_mfma_f32_16x16x32_bf16 v[116:119], a[76:79], a[48:51], v[116:119]
ds_read_b128 a[4:7], v44 offset:36864
v_mfma_f32_16x16x32_bf16 v[120:123], a[76:79], a[52:55], v[120:123]
ds_read_b128 a[8:11], v44 offset:38912
v_mfma_f32_16x16x32_bf16 v[124:127], a[76:79], a[56:59], v[124:127]
ds_read_b128 a[12:15], v44 offset:40960
v_mfma_f32_16x16x32_bf16 v[128:131], a[76:79], a[60:63], v[128:131]
s_mov_b64 exec, s[52:53]
buffer_load_dwordx4 v39, s[28:31], s14 offen offset:1024 lds
s_mov_b64 exec, -1
v_mfma_f32_16x16x32_bf16 v[92:95], a[72:75], a[44:47], v[92:95]
ds_read_b128 a[16:19], v44 offset:43008
v_mfma_f32_16x16x32_bf16 v[96:99], a[72:75], a[48:51], v[96:99]
ds_read_b64_tr_b16 a[28:29], v48 offset:1024
buffer_load_dwordx4 v40, s[28:31], s14 offen offset:2048 lds
v_mfma_f32_16x16x32_bf16 v[100:103], a[72:75], a[52:55], v[100:103]
v_mfma_f32_16x16x32_bf16 v[104:107], a[72:75], a[56:59], v[104:107]
ds_read_b64_tr_b16 a[30:31], v48 offset:1536
v_mfma_f32_16x16x32_bf16 v[108:111], a[72:75], a[60:63], v[108:111]
ds_read_b64_tr_b16 a[32:33], v49 offset:1024
v_mfma_f32_16x16x32_bf16 v[152:155], a[84:87], a[44:47], v[152:155]
s_add_u32 m0, s68, 92160
v_mfma_f32_16x16x32_bf16 v[156:159], a[84:87], a[48:51], v[156:159]
ds_read_b64_tr_b16 a[34:35], v49 offset:1536
v_mfma_f32_16x16x32_bf16 v[160:163], a[84:87], a[52:55], v[160:163]
ds_read_b64_tr_b16 a[36:37], v48 offset:2048
v_mfma_f32_16x16x32_bf16 v[164:167], a[84:87], a[56:59], v[164:167]
buffer_load_dwordx4 v41, s[28:31], s14 offen offset:0 lds
ds_read_b64_tr_b16 a[38:39], v48 offset:2560
v_mfma_f32_16x16x32_bf16 v[168:171], a[84:87], a[60:63], v[168:171]
v_mfma_f32_16x16x32_bf16 v[132:135], a[80:83], a[44:47], v[132:135]
ds_read_b64_tr_b16 a[40:41], v49 offset:2048
v_mfma_f32_16x16x32_bf16 v[136:139], a[80:83], a[48:51], v[136:139]
ds_read_b64_tr_b16 a[42:43], v49 offset:2560
v_mfma_f32_16x16x32_bf16 v[140:143], a[80:83], a[52:55], v[140:143]
s_mov_b64 exec, s[52:53]
buffer_load_dwordx4 v42, s[28:31], s14 offen offset:1024 lds
s_mov_b64 exec, -1
v_mfma_f32_16x16x32_bf16 v[144:147], a[80:83], a[56:59], v[144:147]
ds_read_b64_tr_b16 a[20:21], v48 offset:0
v_mfma_f32_16x16x32_bf16 v[148:151], a[80:83], a[60:63], v[148:151]
ds_read_b64_tr_b16 a[22:23], v48 offset:512
buffer_load_dwordx4 v43, s[28:31], s14 offen offset:2048 lds
PADQ1:
s_cbranch_execz BACK_Q
v_mfma_f32_16x16x32_bf16 v[72:75], a[68:71], a[44:47], v[72:75]
ds_read_b64_tr_b16 a[24:25], v49 offset:0
v_mfma_f32_16x16x32_bf16 v[76:79], a[68:71], a[48:51], v[76:79]
v_mfma_f32_16x16x32_bf16 v[80:83], a[68:71], a[52:55], v[80:83]
ds_read_b64_tr_b16 a[26:27], v49 offset:512
s_add_u32 m0, s69, 20480
v_mfma_f32_16x16x32_bf16 v[84:87], a[68:71], a[56:59], v[84:87]
v_mfma_f32_16x16x32_bf16 v[88:91], a[68:71], a[60:63], v[88:91]
v_mfma_f32_16x16x32_bf16 v[52:55], a[64:67], a[44:47], v[52:55]
buffer_load_dwordx4 v33, s[24:27], s9 offen offset:0 lds
v_mfma_f32_16x16x32_bf16 v[56:59], a[64:67], a[48:51], v[56:59]
v_mfma_f32_16x16x32_bf16 v[60:63], a[64:67], a[52:55], v[60:63]
v_mfma_f32_16x16x32_bf16 v[64:67], a[64:67], a[56:59], v[64:67]
v_mfma_f32_16x16x32_bf16 v[68:71], a[64:67], a[60:63], v[68:71]
s_waitcnt vmcnt(12) lgkmcnt(0)
s_barrier
v_mfma_f32_16x16x32_bf16 v[112:115], a[32:35], a[0:3], v[112:115]
ds_read_b128 a[44:47], v47 offset:36864
s_add_u32 m0, s69, 20480
v_mfma_f32_16x16x32_bf16 v[116:119], a[32:35], a[4:7], v[116:119]
ds_read_b128 a[48:51], v45 offset:36864
v_mfma_f32_16x16x32_bf16 v[120:123], a[32:35], a[8:11], v[120:123]
ds_read_b128 a[52:55], v45 offset:38912
v_mfma_f32_16x16x32_bf16 v[124:127], a[32:35], a[12:15], v[124:127]
buffer_load_dwordx4 v34, s[24:27], s9 offen offset:1024 lds
ds_read_b128 a[56:59], v45 offset:40960
v_mfma_f32_16x16x32_bf16 v[128:131], a[32:35], a[16:19], v[128:131]
v_mfma_f32_16x16x32_bf16 v[92:95], a[28:31], a[0:3], v[92:95]
ds_read_b128 a[60:63], v45 offset:43008
v_mfma_f32_16x16x32_bf16 v[96:99], a[28:31], a[4:7], v[96:99]
ds_read_b64_tr_b16 a[72:73], v48 offset:13312
buffer_load_dwordx4 v35, s[24:27], s9 offen offset:2048 lds
v_mfma_f32_16x16x32_bf16 v[100:103], a[28:31], a[8:11], v[100:103]
v_mfma_f32_16x16x32_bf16 v[104:107], a[28:31], a[12:15], v[104:107]
ds_read_b64_tr_b16 a[74:75], v48 offset:13824
v_mfma_f32_16x16x32_bf16 v[108:111], a[28:31], a[16:19], v[108:111]
ds_read_b64_tr_b16 a[76:77], v49 offset:13312
v_mfma_f32_16x16x32_bf16 v[152:155], a[40:43], a[0:3], v[152:155]
buffer_load_dwordx4 v36, s[24:27], s9 offen offset:3072 lds
v_mfma_f32_16x16x32_bf16 v[156:159], a[40:43], a[4:7], v[156:159]
ds_read_b64_tr_b16 a[78:79], v49 offset:13824
v_mfma_f32_16x16x32_bf16 v[160:163], a[40:43], a[8:11], v[160:163]
ds_read_b64_tr_b16 a[80:81], v48 offset:14336
v_mfma_f32_16x16x32_bf16 v[164:167], a[40:43], a[12:15], v[164:167]
s_mov_b32 m0, 19456
ds_read_b64_tr_b16 a[82:83], v48 offset:14848
v_mfma_f32_16x16x32_bf16 v[168:171], a[40:43], a[16:19], v[168:171]
v_mfma_f32_16x16x32_bf16 v[132:135], a[36:39], a[0:3], v[132:135]
ds_read_b64_tr_b16 a[84:85], v49 offset:14336
v_mfma_f32_16x16x32_bf16 v[136:139], a[36:39], a[4:7], v[136:139]
ds_read_b64_tr_b16 a[86:87], v49 offset:14848
v_mfma_f32_16x16x32_bf16 v[140:143], a[36:39], a[8:11], v[140:143]
s_mov_b64 exec, s[54:55]
buffer_load_dwordx4 v37, s[24:27], s9 offen lds
s_mov_b64 exec, -1
v_mfma_f32_16x16x32_bf16 v[144:147], a[36:39], a[12:15], v[144:147]
ds_read_b64_tr_b16 a[64:65], v48 offset:12288
v_mfma_f32_16x16x32_bf16 v[148:151], a[36:39], a[16:19], v[148:151]
ds_read_b64_tr_b16 a[66:67], v48 offset:12800
s_add_u32 m0, s68, 55296
v_mfma_f32_16x16x32_bf16 v[72:75], a[24:27], a[0:3], v[72:75]
ds_read_b64_tr_b16 a[68:69], v49 offset:12288
v_mfma_f32_16x16x32_bf16 v[76:79], a[24:27], a[4:7], v[76:79]
v_mfma_f32_16x16x32_bf16 v[80:83], a[24:27], a[8:11], v[80:83]
ds_read_b64_tr_b16 a[70:71], v49 offset:12800
buffer_load_dwordx4 v38, s[28:31], s15 offen offset:0 lds
v_mfma_f32_16x16x32_bf16 v[84:87], a[24:27], a[12:15], v[84:87]
v_mfma_f32_16x16x32_bf16 v[88:91], a[24:27], a[16:19], v[88:91]
v_mfma_f32_16x16x32_bf16 v[52:55], a[20:23], a[0:3], v[52:55]
v_mfma_f32_16x16x32_bf16 v[56:59], a[20:23], a[4:7], v[56:59]
s_mov_b64 exec, s[52:53]
buffer_load_dwordx4 v39, s[28:31], s15 offen offset:1024 lds
s_mov_b64 exec, -1
v_mfma_f32_16x16x32_bf16 v[60:63], a[20:23], a[8:11], v[60:63]
v_mfma_f32_16x16x32_bf16 v[64:67], a[20:23], a[12:15], v[64:67]
v_mfma_f32_16x16x32_bf16 v[68:71], a[20:23], a[16:19], v[68:71]
s_waitcnt vmcnt(10) lgkmcnt(0)
s_barrier
v_mfma_f32_16x16x32_bf16 v[112:115], a[76:79], a[44:47], v[112:115]
ds_read_b128 a[0:3], v46 offset:0
s_add_u32 m0, s68, 55296
v_mfma_f32_16x16x32_bf16 v[116:119], a[76:79], a[48:51], v[116:119]
ds_read_b128 a[4:7], v44 offset:0
v_mfma_f32_16x16x32_bf16 v[120:123], a[76:79], a[52:55], v[120:123]
ds_read_b128 a[8:11], v44 offset:2048
v_mfma_f32_16x16x32_bf16 v[124:127], a[76:79], a[56:59], v[124:127]
buffer_load_dwordx4 v40, s[28:31], s15 offen offset:2048 lds
ds_read_b128 a[12:15], v44 offset:4096
v_mfma_f32_16x16x32_bf16 v[128:131], a[76:79], a[60:63], v[128:131]
v_mfma_f32_16x16x32_bf16 v[92:95], a[72:75], a[44:47], v[92:95]
ds_read_b128 a[16:19], v44 offset:6144
v_mfma_f32_16x16x32_bf16 v[96:99], a[72:75], a[48:51], v[96:99]
ds_read_b64_tr_b16 a[28:29], v48 offset:25600
s_add_u32 m0, s68, 67584
v_mfma_f32_16x16x32_bf16 v[100:103], a[72:75], a[52:55], v[100:103]
v_mfma_f32_16x16x32_bf16 v[104:107], a[72:75], a[56:59], v[104:107]
ds_read_b64_tr_b16 a[30:31], v48 offset:26112
v_mfma_f32_16x16x32_bf16 v[108:111], a[72:75], a[60:63], v[108:111]
ds_read_b64_tr_b16 a[32:33], v49 offset:25600
v_mfma_f32_16x16x32_bf16 v[152:155], a[84:87], a[44:47], v[152:155]
buffer_load_dwordx4 v41, s[28:31], s15 offen offset:0 lds
v_mfma_f32_16x16x32_bf16 v[156:159], a[84:87], a[48:51], v[156:159]
ds_read_b64_tr_b16 a[34:35], v49 offset:26112
v_mfma_f32_16x16x32_bf16 v[160:163], a[84:87], a[52:55], v[160:163]
ds_read_b64_tr_b16 a[36:37], v48 offset:26624
v_mfma_f32_16x16x32_bf16 v[164:167], a[84:87], a[56:59], v[164:167]
ds_read_b64_tr_b16 a[38:39], v48 offset:27136
v_mfma_f32_16x16x32_bf16 v[168:171], a[84:87], a[60:63], v[168:171]
s_mov_b64 exec, s[52:53]
buffer_load_dwordx4 v42, s[28:31], s15 offen offset:1024 lds
s_mov_b64 exec, -1
v_mfma_f32_16x16x32_bf16 v[132:135], a[80:83], a[44:47], v[132:135]
ds_read_b64_tr_b16 a[40:41], v49 offset:26624
v_mfma_f32_16x16x32_bf16 v[136:139], a[80:83], a[48:51], v[136:139]
buffer_load_dwordx4 v43, s[28:31], s15 offen offset:2048 lds
ds_read_b64_tr_b16 a[42:43], v49 offset:27136
v_mfma_f32_16x16x32_bf16 v[140:143], a[80:83], a[52:55], v[140:143]
v_mfma_f32_16x16x32_bf16 v[144:147], a[80:83], a[56:59], v[144:147]
ds_read_b64_tr_b16 a[20:21], v48 offset:24576
v_mfma_f32_16x16x32_bf16 v[148:151], a[80:83], a[60:63], v[148:151]
ds_read_b64_tr_b16 a[22:23], v48 offset:25088
s_add_u32 m0, s69, 38912
v_mfma_f32_16x16x32_bf16 v[72:75], a[68:71], a[44:47], v[72:75]
ds_read_b64_tr_b16 a[24:25], v49 offset:24576
v_mfma_f32_16x16x32_bf16 v[76:79], a[68:71], a[48:51], v[76:79]
v_mfma_f32_16x16x32_bf16 v[80:83], a[68:71], a[52:55], v[80:83]
ds_read_b64_tr_b16 a[26:27], v49 offset:25088
buffer_load_dwordx4 v33, s[24:27], s10 offen offset:0 lds
v_mfma_f32_16x16x32_bf16 v[84:87], a[68:71], a[56:59], v[84:87]
v_mfma_f32_16x16x32_bf16 v[88:91], a[68:71], a[60:63], v[88:91]
v_mfma_f32_16x16x32_bf16 v[52:55], a[64:67], a[44:47], v[52:55]
buffer_load_dwordx4 v34, s[24:27], s10 offen offset:1024 lds
v_mfma_f32_16x16x32_bf16 v[56:59], a[64:67], a[48:51], v[56:59]
v_mfma_f32_16x16x32_bf16 v[60:63], a[64:67], a[52:55], v[60:63]
v_mfma_f32_16x16x32_bf16 v[64:67], a[64:67], a[56:59], v[64:67]
v_mfma_f32_16x16x32_bf16 v[68:71], a[64:67], a[60:63], v[68:71]
s_waitcnt vmcnt(13) lgkmcnt(0)
s_barrier
v_mfma_f32_16x16x32_bf16 v[112:115], a[32:35], a[0:3], v[112:115]
ds_read_b128 a[44:47], v47 offset:0
buffer_load_dword v29, v28, s[44:47], 0 offen sc1
v_mfma_f32_16x16x32_bf16 v[116:119], a[32:35], a[4:7], v[116:119]
ds_read_b128 a[48:51], v45 offset:0
v_mfma_f32_16x16x32_bf16 v[120:123], a[32:35], a[8:11], v[120:123]
ds_read_b128 a[52:55], v45 offset:2048
v_mfma_f32_16x16x32_bf16 v[124:127], a[32:35], a[12:15], v[124:127]
s_add_u32 m0, s69, 38912
ds_read_b128 a[56:59], v45 offset:4096
v_mfma_f32_16x16x32_bf16 v[128:131], a[32:35], a[16:19], v[128:131]
v_mfma_f32_16x16x32_bf16 v[92:95], a[28:31], a[0:3], v[92:95]
ds_read_b128 a[60:63], v45 offset:6144
v_mfma_f32_16x16x32_bf16 v[96:99], a[28:31], a[4:7], v[96:99]
buffer_load_dwordx4 v35, s[24:27], s10 offen offset:2048 lds
ds_read_b64_tr_b16 a[72:73], v48 offset:37888
v_mfma_f32_16x16x32_bf16 v[100:103], a[28:31], a[8:11], v[100:103]
v_mfma_f32_16x16x32_bf16 v[104:107], a[28:31], a[12:15], v[104:107]
ds_read_b64_tr_b16 a[74:75], v48 offset:38400
buffer_load_dwordx4 v36, s[24:27], s10 offen offset:3072 lds
v_mfma_f32_16x16x32_bf16 v[108:111], a[28:31], a[16:19], v[108:111]
ds_read_b64_tr_b16 a[76:77], v49 offset:37888
v_mfma_f32_16x16x32_bf16 v[152:155], a[40:43], a[0:3], v[152:155]
v_mfma_f32_16x16x32_bf16 v[156:159], a[40:43], a[4:7], v[156:159]
ds_read_b64_tr_b16 a[78:79], v49 offset:38400
s_mov_b32 m0, 37888
v_mfma_f32_16x16x32_bf16 v[160:163], a[40:43], a[8:11], v[160:163]
ds_read_b64_tr_b16 a[80:81], v48 offset:38912
v_mfma_f32_16x16x32_bf16 v[164:167], a[40:43], a[12:15], v[164:167]
ds_read_b64_tr_b16 a[82:83], v48 offset:39424
v_mfma_f32_16x16x32_bf16 v[168:171], a[40:43], a[16:19], v[168:171]
v_mfma_f32_16x16x32_bf16 v[132:135], a[36:39], a[0:3], v[132:135]
ds_read_b64_tr_b16 a[84:85], v49 offset:38912
v_mfma_f32_16x16x32_bf16 v[136:139], a[36:39], a[4:7], v[136:139]
ds_read_b64_tr_b16 a[86:87], v49 offset:39424
v_mfma_f32_16x16x32_bf16 v[140:143], a[36:39], a[8:11], v[140:143]
s_mov_b64 exec, s[54:55]
buffer_load_dwordx4 v37, s[24:27], s10 offen lds
s_mov_b64 exec, -1
v_mfma_f32_16x16x32_bf16 v[144:147], a[36:39], a[12:15], v[144:147]
s_add_u32 m0, s68, 79872
ds_read_b64_tr_b16 a[64:65], v48 offset:36864
v_mfma_f32_16x16x32_bf16 v[148:151], a[36:39], a[16:19], v[148:151]
ds_read_b64_tr_b16 a[66:67], v48 offset:37376
v_mfma_f32_16x16x32_bf16 v[72:75], a[24:27], a[0:3], v[72:75]
buffer_load_dwordx4 v38, s[28:31], s18 offen offset:0 lds
ds_read_b64_tr_b16 a[68:69], v49 offset:36864
v_mfma_f32_16x16x32_bf16 v[76:79], a[24:27], a[4:7], v[76:79]
v_mfma_f32_16x16x32_bf16 v[80:83], a[24:27], a[8:11], v[80:83]
ds_read_b64_tr_b16 a[70:71], v49 offset:37376
v_mfma_f32_16x16x32_bf16 v[84:87], a[24:27], a[12:15], v[84:87]
v_mfma_f32_16x16x32_bf16 v[88:91], a[24:27], a[16:19], v[88:91]
s_mov_b64 exec, s[52:53]
buffer_load_dwordx4 v39, s[28:31], s18 offen offset:1024 lds
s_mov_b64 exec, -1
v_mfma_f32_16x16x32_bf16 v[52:55], a[20:23], a[0:3], v[52:55]
v_mfma_f32_16x16x32_bf16 v[56:59], a[20:23], a[4:7], v[56:59]
buffer_load_dwordx4 v40, s[28:31], s18 offen offset:2048 lds
v_mfma_f32_16x16x32_bf16 v[60:63], a[20:23], a[8:11], v[60:63]
v_mfma_f32_16x16x32_bf16 v[64:67], a[20:23], a[12:15], v[64:67]
v_mfma_f32_16x16x32_bf16 v[68:71], a[20:23], a[16:19], v[68:71]
s_waitcnt vmcnt(12) lgkmcnt(0)
s_barrier
v_mfma_f32_16x16x32_bf16 v[112:115], a[76:79], a[44:47], v[112:115]
ds_read_b128 a[0:3], v46 offset:18432
s_add_u32 m0, s68, 92160
v_mfma_f32_16x16x32_bf16 v[116:119], a[76:79], a[48:51], v[116:119]
ds_read_b128 a[4:7], v44 offset:18432
v_mfma_f32_16x16x32_bf16 v[120:123], a[76:79], a[52:55], v[120:123]
ds_read_b128 a[8:11], v44 offset:20480
v_mfma_f32_16x16x32_bf16 v[124:127], a[76:79], a[56:59], v[124:127]
ds_read_b128 a[12:15], v44 offset:22528
v_mfma_f32_16x16x32_bf16 v[128:131], a[76:79], a[60:63], v[128:131]
buffer_load_dwordx4 v41, s[28:31], s18 offen offset:0 lds
v_mfma_f32_16x16x32_bf16 v[92:95], a[72:75], a[44:47], v[92:95]
ds_read_b128 a[16:19], v44 offset:24576
v_mfma_f32_16x16x32_bf16 v[96:99], a[72:75], a[48:51], v[96:99]
ds_read_b64_tr_b16 a[28:29], v48 offset:1024
v_mfma_f32_16x16x32_bf16 v[100:103], a[72:75], a[52:55], v[100:103]
v_mfma_f32_16x16x32_bf16 v[104:107], a[72:75], a[56:59], v[104:107]
ds_read_b64_tr_b16 a[30:31], v48 offset:1536
v_mfma_f32_16x16x32_bf16 v[108:111], a[72:75], a[60:63], v[108:111]
ds_read_b64_tr_b16 a[32:33], v49 offset:1024
v_mfma_f32_16x16x32_bf16 v[152:155], a[84:87], a[44:47], v[152:155]
s_mov_b64 exec, s[52:53]
buffer_load_dwordx4 v42, s[28:31], s18 offen offset:1024 lds
s_mov_b64 exec, -1
v_mfma_f32_16x16x32_bf16 v[156:159], a[84:87], a[48:51], v[156:159]
ds_read_b64_tr_b16 a[34:35], v49 offset:1536
buffer_load_dwordx4 v43, s[28:31], s18 offen offset:2048 lds
v_mfma_f32_16x16x32_bf16 v[160:163], a[84:87], a[52:55], v[160:163]
ds_read_b64_tr_b16 a[36:37], v48 offset:2048
v_mfma_f32_16x16x32_bf16 v[164:167], a[84:87], a[56:59], v[164:167]
ds_read_b64_tr_b16 a[38:39], v48 offset:2560
v_mfma_f32_16x16x32_bf16 v[168:171], a[84:87], a[60:63], v[168:171]
v_mfma_f32_16x16x32_bf16 v[132:135], a[80:83], a[44:47], v[132:135]
s_add_u32 m0, s69, 2048
ds_read_b64_tr_b16 a[40:41], v49 offset:2048
v_mfma_f32_16x16x32_bf16 v[136:139], a[80:83], a[48:51], v[136:139]
ds_read_b64_tr_b16 a[42:43], v49 offset:2560
v_mfma_f32_16x16x32_bf16 v[140:143], a[80:83], a[52:55], v[140:143]
v_mfma_f32_16x16x32_bf16 v[144:147], a[80:83], a[56:59], v[144:147]
ds_read_b64_tr_b16 a[20:21], v48 offset:0
buffer_load_dwordx4 v33, s[24:27], s11 offen offset:0 lds
v_mfma_f32_16x16x32_bf16 v[148:151], a[80:83], a[60:63], v[148:151]
ds_read_b64_tr_b16 a[22:23], v48 offset:512
v_mfma_f32_16x16x32_bf16 v[72:75], a[68:71], a[44:47], v[72:75]
ds_read_b64_tr_b16 a[24:25], v49 offset:0
v_mfma_f32_16x16x32_bf16 v[76:79], a[68:71], a[48:51], v[76:79]
v_mfma_f32_16x16x32_bf16 v[80:83], a[68:71], a[52:55], v[80:83]
buffer_load_dwordx4 v34, s[24:27], s11 offen offset:1024 lds
ds_read_b64_tr_b16 a[26:27], v49 offset:512
v_mfma_f32_16x16x32_bf16 v[84:87], a[68:71], a[56:59], v[84:87]
v_mfma_f32_16x16x32_bf16 v[88:91], a[68:71], a[60:63], v[88:91]
v_mfma_f32_16x16x32_bf16 v[52:55], a[64:67], a[44:47], v[52:55]
buffer_load_dwordx4 v35, s[24:27], s11 offen offset:2048 lds
v_mfma_f32_16x16x32_bf16 v[56:59], a[64:67], a[48:51], v[56:59]
v_mfma_f32_16x16x32_bf16 v[60:63], a[64:67], a[52:55], v[60:63]
v_mfma_f32_16x16x32_bf16 v[64:67], a[64:67], a[56:59], v[64:67]
v_mfma_f32_16x16x32_bf16 v[68:71], a[64:67], a[60:63], v[68:71]
s_waitcnt vmcnt(15) lgkmcnt(0)
s_barrier
v_mfma_f32_16x16x32_bf16 v[112:115], a[32:35], a[0:3], v[112:115]
ds_read_b128 a[44:47], v47 offset:18432
s_add_u32 m0, s69, 2048
v_mfma_f32_16x16x32_bf16 v[116:119], a[32:35], a[4:7], v[116:119]
ds_read_b128 a[48:51], v45 offset:18432
v_mfma_f32_16x16x32_bf16 v[120:123], a[32:35], a[8:11], v[120:123]
ds_read_b128 a[52:55], v45 offset:20480
v_mfma_f32_16x16x32_bf16 v[124:127], a[32:35], a[12:15], v[124:127]
ds_read_b128 a[56:59], v45 offset:22528
v_mfma_f32_16x16x32_bf16 v[128:131], a[32:35], a[16:19], v[128:131]
buffer_load_dwordx4 v36, s[24:27], s11 offen offset:3072 lds
v_mfma_f32_16x16x32_bf16 v[92:95], a[28:31], a[0:3], v[92:95]
ds_read_b128 a[60:63], v45 offset:24576
v_mfma_f32_16x16x32_bf16 v[96:99], a[28:31], a[4:7], v[96:99]
ds_read_b64_tr_b16 a[72:73], v48 offset:13312
v_mfma_f32_16x16x32_bf16 v[100:103], a[28:31], a[8:11], v[100:103]
s_mov_b32 m0, 1024
v_mfma_f32_16x16x32_bf16 v[104:107], a[28:31], a[12:15], v[104:107]
ds_read_b64_tr_b16 a[74:75], v48 offset:13824
v_mfma_f32_16x16x32_bf16 v[108:111], a[28:31], a[16:19], v[108:111]
ds_read_b64_tr_b16 a[76:77], v49 offset:13312
v_mfma_f32_16x16x32_bf16 v[152:155], a[40:43], a[0:3], v[152:155]
s_waitcnt vmcnt(13)
v_readfirstlane_b32 s86, v29
s_nop 0
s_cmp_eq_u32 s86, 0
s_cbranch_scc1 TAGSL_Q
TAGOK_Q:
v_mfma_f32_16x16x32_bf16 v[156:159], a[40:43], a[4:7], v[156:159]
ds_read_b64_tr_b16 a[78:79], v49 offset:13824
v_mfma_f32_16x16x32_bf16 v[160:163], a[40:43], a[8:11], v[160:163]
ds_read_b64_tr_b16 a[80:81], v48 offset:14336
v_mfma_f32_16x16x32_bf16 v[164:167], a[40:43], a[12:15], v[164:167]
ds_read_b64_tr_b16 a[82:83], v48 offset:14848
v_mfma_f32_16x16x32_bf16 v[168:171], a[40:43], a[16:19], v[168:171]
buffer_load_dwordx4 v[172:175], v221, s[32:35], 0 offen offset:0 sc1
v_mfma_f32_16x16x32_bf16 v[132:135], a[36:39], a[0:3], v[132:135]
ds_read_b64_tr_b16 a[84:85], v49 offset:14336
v_mfma_f32_16x16x32_bf16 v[136:139], a[36:39], a[4:7], v[136:139]
ds_read_b64_tr_b16 a[86:87], v49 offset:14848
s_mov_b64 exec, s[54:55]
buffer_load_dwordx4 v37, s[24:27], s11 offen lds
s_mov_b64 exec, -1
v_mfma_f32_16x16x32_bf16 v[140:143], a[36:39], a[8:11], v[140:143]
s_add_u32 m0, s68, 55296
v_mfma_f32_16x16x32_bf16 v[144:147], a[36:39], a[12:15], v[144:147]
ds_read_b64_tr_b16 a[64:65], v48 offset:12288
buffer_load_dwordx4 v38, s[28:31], s19 offen offset:0 lds
v_mfma_f32_16x16x32_bf16 v[148:151], a[36:39], a[16:19], v[148:151]
ds_read_b64_tr_b16 a[66:67], v48 offset:12800
v_mfma_f32_16x16x32_bf16 v[72:75], a[24:27], a[0:3], v[72:75]
ds_read_b64_tr_b16 a[68:69], v49 offset:12288
v_mfma_f32_16x16x32_bf16 v[76:79], a[24:27], a[4:7], v[76:79]
v_mfma_f32_16x16x32_bf16 v[80:83], a[24:27], a[8:11], v[80:83]
ds_read_b64_tr_b16 a[70:71], v49 offset:12800
v_mfma_f32_16x16x32_bf16 v[84:87], a[24:27], a[12:15], v[84:87]
s_mov_b64 exec, s[52:53]
buffer_load_dwordx4 v39, s[28:31], s19 offen offset:1024 lds
s_mov_b64 exec, -1
v_mfma_f32_16x16x32_bf16 v[88:91], a[24:27], a[16:19], v[88:91]
buffer_load_dwordx4 v[176:179], v221, s[32:35], 0 offen offset:512 sc1
v_mfma_f32_16x16x32_bf16 v[52:55], a[20:23], a[0:3], v[52:55]
buffer_load_dwordx4 v40, s[28:31], s19 offen offset:2048 lds
v_mfma_f32_16x16x32_bf16 v[56:59], a[20:23], a[4:7], v[56:59]
v_mfma_f32_16x16x32_bf16 v[60:63], a[20:23], a[8:11], v[60:63]
v_mfma_f32_16x16x32_bf16 v[64:67], a[20:23], a[12:15], v[64:67]
v_mfma_f32_16x16x32_bf16 v[68:71], a[20:23], a[16:19], v[68:71]
s_waitcnt vmcnt(13) lgkmcnt(0)
s_barrier
v_mfma_f32_16x16x32_bf16 v[112:115], a[76:79], a[44:47], v[112:115]
ds_read_b128 a[0:3], v46 offset:36864
s_add_u32 m0, s68, 67584
v_mfma_f32_16x16x32_bf16 v[116:119], a[76:79], a[48:51], v[116:119]
ds_read_b128 a[4:7], v44 offset:36864
v_mfma_f32_16x16x32_bf16 v[120:123], a[76:79], a[52:55], v[120:123]
ds_read_b128 a[8:11], v44 offset:38912
v_mfma_f32_16x16x32_bf16 v[124:127], a[76:79], a[56:59], v[124:127]
ds_read_b128 a[12:15], v44 offset:40960
v_mfma_f32_16x16x32_bf16 v[128:131], a[76:79], a[60:63], v[128:131]
buffer_load_dwordx4 v41, s[28:31], s19 offen offset:0 lds
v_mfma_f32_16x16x32_bf16 v[92:95], a[72:75], a[44:47], v[92:95]
ds_read_b128 a[16:19], v44 offset:43008
v_mfma_f32_16x16x32_bf16 v[96:99], a[72:75], a[48:51], v[96:99]
ds_read_b64_tr_b16 a[28:29], v48 offset:25600
v_mfma_f32_16x16x32_bf16 v[100:103], a[72:75], a[52:55], v[100:103]
buffer_load_dwordx4 v[180:183], v221, s[32:35], 0 offen offset:1024 sc1
v_mfma_f32_16x16x32_bf16 v[104:107], a[72:75], a[56:59], v[104:107]
ds_read_b64_tr_b16 a[30:31], v48 offset:26112
v_mfma_f32_16x16x32_bf16 v[108:111], a[72:75], a[60:63], v[108:111]
ds_read_b64_tr_b16 a[32:33], v49 offset:25600
v_mfma_f32_16x16x32_bf16 v[152:155], a[84:87], a[44:47], v[152:155]
s_mov_b64 exec, s[52:53]
buffer_load_dwordx4 v42, s[28:31], s19 offen offset:1024 lds
s_mov_b64 exec, -1
v_mfma_f32_16x16x32_bf16 v[156:159], a[84:87], a[48:51], v[156:159]
ds_read_b64_tr_b16 a[34:35], v49 offset:26112
buffer_load_dwordx4 v43, s[28:31], s19 offen offset:2048 lds
v_mfma_f32_16x16x32_bf16 v[160:163], a[84:87], a[52:55], v[160:163]
ds_read_b64_tr_b16 a[36:37], v48 offset:26624
v_mfma_f32_16x16x32_bf16 v[164:167], a[84:87], a[56:59], v[164:167]
ds_read_b64_tr_b16 a[38:39], v48 offset:27136
v_mfma_f32_16x16x32_bf16 v[168:171], a[84:87], a[60:63], v[168:171]
v_mfma_f32_16x16x32_bf16 v[132:135], a[80:83], a[44:47], v[132:135]
s_add_u32 m0, s85, 106496
ds_read_b64_tr_b16 a[40:41], v49 offset:26624
v_mfma_f32_16x16x32_bf16 v[136:139], a[80:83], a[48:51], v[136:139]
ds_read_b64_tr_b16 a[42:43], v49 offset:27136
v_mfma_f32_16x16x32_bf16 v[140:143], a[80:83], a[52:55], v[140:143]
v_mfma_f32_16x16x32_bf16 v[144:147], a[80:83], a[56:59], v[144:147]
ds_read_b64_tr_b16 a[20:21], v48 offset:24576
buffer_load_dwordx4 v12, s[36:39], s76 offen offset:0 lds
v_mfma_f32_16x16x32_bf16 v[148:151], a[80:83], a[60:63], v[148:151]
ds_read_b64_tr_b16 a[22:23], v48 offset:25088
v_mfma_f32_16x16x32_bf16 v[72:75], a[68:71], a[44:47], v[72:75]
ds_read_b64_tr_b16 a[24:25], v49 offset:24576
v_mfma_f32_16x16x32_bf16 v[76:79], a[68:71], a[48:51], v[76:79]
buffer_load_dwordx4 v[204:207], v221, s[32:35], 0 offen offset:1536 sc1
v_mfma_f32_16x16x32_bf16 v[80:83], a[68:71], a[52:55], v[80:83]
buffer_load_dwordx4 v13, s[36:39], s76 offen offset:1024 lds
ds_read_b64_tr_b16 a[26:27], v49 offset:25088
v_mfma_f32_16x16x32_bf16 v[84:87], a[68:71], a[56:59], v[84:87]
v_mfma_f32_16x16x32_bf16 v[88:91], a[68:71], a[60:63], v[88:91]
v_mfma_f32_16x16x32_bf16 v[52:55], a[64:67], a[44:47], v[52:55]
s_add_u32 s76, s76, 14336
v_mfma_f32_16x16x32_bf16 v[56:59], a[64:67], a[48:51], v[56:59]
v_mfma_f32_16x16x32_bf16 v[60:63], a[64:67], a[52:55], v[60:63]
v_mfma_f32_16x16x32_bf16 v[64:67], a[64:67], a[56:59], v[64:67]
v_mfma_f32_16x16x32_bf16 v[68:71], a[64:67], a[60:63], v[68:71]
s_waitcnt vmcnt(17) lgkmcnt(0)
s_barrier
v_mfma_f32_16x16x32_bf16 v[112:115], a[32:35], a[0:3], v[112:115]
ds_read_b128 a[44:47], v47 offset:36864
s_add_u32 m0, s85, 114688
v_mfma_f32_16x16x32_bf16 v[116:119], a[32:35], a[4:7], v[116:119]
ds_read_b128 a[48:51], v45 offset:36864
v_mfma_f32_16x16x32_bf16 v[120:123], a[32:35], a[8:11], v[120:123]
ds_read_b128 a[52:55], v45 offset:38912
v_mfma_f32_16x16x32_bf16 v[124:127], a[32:35], a[12:15], v[124:127]
buffer_load_dwordx4 v12, s[36:39], s76 offen offset:0 lds
ds_read_b128 a[56:59], v45 offset:40960
v_mfma_f32_16x16x32_bf16 v[128:131], a[32:35], a[16:19], v[128:131]
v_mfma_f32_16x16x32_bf16 v[92:95], a[28:31], a[0:3], v[92:95]
buffer_load_dwordx4 v[208:211], v221, s[32:35], 0 offen offset:2048 sc1
ds_read_b128 a[60:63], v45 offset:43008
v_mfma_f32_16x16x32_bf16 v[96:99], a[28:31], a[4:7], v[96:99]
ds_read_b64_tr_b16 a[72:73], v48 offset:37888
buffer_load_dwordx4 v13, s[36:39], s76 offen offset:1024 lds
v_mfma_f32_16x16x32_bf16 v[100:103], a[28:31], a[8:11], v[100:103]
v_mfma_f32_16x16x32_bf16 v[104:107], a[28:31], a[12:15], v[104:107]
ds_read_b64_tr_b16 a[74:75], v48 offset:38400
v_mfma_f32_16x16x32_bf16 v[108:111], a[28:31], a[16:19], v[108:111]
ds_read_b64_tr_b16 a[76:77], v49 offset:37888
v_mfma_f32_16x16x32_bf16 v[152:155], a[40:43], a[0:3], v[152:155]
s_add_u32 s76, s76, 14336
v_mfma_f32_16x16x32_bf16 v[156:159], a[40:43], a[4:7], v[156:159]
ds_read_b64_tr_b16 a[78:79], v49 offset:38400
v_mfma_f32_16x16x32_bf16 v[160:163], a[40:43], a[8:11], v[160:163]
ds_read_b64_tr_b16 a[80:81], v48 offset:38912
v_mfma_f32_16x16x32_bf16 v[164:167], a[40:43], a[12:15], v[164:167]
s_cmp_eq_u32 s76, s79
s_cselect_b32 s76, s78, s76
v_mfma_f32_16x16x32_bf16 v[168:171], a[40:43], a[16:19], v[168:171]
ds_read_b64_tr_b16 a[82:83], v48 offset:39424
buffer_load_dwordx4 v[212:215], v221, s[32:35], 0 offen offset:2560 sc1
v_mfma_f32_16x16x32_bf16 v[132:135], a[36:39], a[0:3], v[132:135]
ds_read_b64_tr_b16 a[84:85], v49 offset:38912
v_mfma_f32_16x16x32_bf16 v[136:139], a[36:39], a[4:7], v[136:139]
s_add_u32 m0, s85, 122880
ds_read_b64_tr_b16 a[86:87], v49 offset:39424
v_mfma_f32_16x16x32_bf16 v[140:143], a[36:39], a[8:11], v[140:143]
v_mfma_f32_16x16x32_bf16 v[144:147], a[36:39], a[12:15], v[144:147]
ds_read_b64_tr_b16 a[64:65], v48 offset:36864
v_mfma_f32_16x16x32_bf16 v[148:151], a[36:39], a[16:19], v[148:151]
ds_read_b64_tr_b16 a[66:67], v48 offset:37376
buffer_load_dwordx4 v12, s[36:39], s76 offen offset:0 lds
v_mfma_f32_16x16x32_bf16 v[72:75], a[24:27], a[0:3], v[72:75]
ds_read_b64_tr_b16 a[68:69], v49 offset:36864
v_mfma_f32_16x16x32_bf16 v[76:79], a[24:27], a[4:7], v[76:79]
v_mfma_f32_16x16x32_bf16 v[80:83], a[24:27], a[8:11], v[80:83]
ds_read_b64_tr_b16 a[70:71], v49 offset:37376
buffer_load_dwordx4 v13, s[36:39], s76 offen offset:1024 lds
v_mfma_f32_16x16x32_bf16 v[84:87], a[24:27], a[12:15], v[84:87]
v_mfma_f32_16x16x32_bf16 v[88:91], a[24:27], a[16:19], v[88:91]
buffer_load_dwordx4 v[216:219], v221, s[32:35], 0 offen offset:3072 sc1
v_mfma_f32_16x16x32_bf16 v[52:55], a[20:23], a[0:3], v[52:55]
s_add_u32 s76, s76, 14336
v_mfma_f32_16x16x32_bf16 v[56:59], a[20:23], a[4:7], v[56:59]
v_mfma_f32_16x16x32_bf16 v[60:63], a[20:23], a[8:11], v[60:63]
v_mfma_f32_16x16x32_bf16 v[64:67], a[20:23], a[12:15], v[64:67]
v_mfma_f32_16x16x32_bf16 v[68:71], a[20:23], a[16:19], v[68:71]
s_waitcnt vmcnt(14) lgkmcnt(0)
s_barrier
v_mfma_f32_16x16x32_bf16 v[112:115], a[76:79], a[44:47], v[112:115]
ds_read_b128 a[0:3], v46 offset:0
s_add_u32 m0, s85, 131072
v_mfma_f32_16x16x32_bf16 v[116:119], a[76:79], a[48:51], v[116:119]
ds_read_b128 a[4:7], v44 offset:0
v_mfma_f32_16x16x32_bf16 v[120:123], a[76:79], a[52:55], v[120:123]
buffer_load_dwordx4 v12, s[36:39], s76 offen offset:0 lds
ds_read_b128 a[8:11], v44 offset:2048
v_mfma_f32_16x16x32_bf16 v[124:127], a[76:79], a[56:59], v[124:127]
ds_read_b128 a[12:15], v44 offset:4096
v_mfma_f32_16x16x32_bf16 v[128:131], a[76:79], a[60:63], v[128:131]
buffer_load_dwordx4 v13, s[36:39], s76 offen offset:1024 lds
v_mfma_f32_16x16x32_bf16 v[92:95], a[72:75], a[44:47], v[92:95]
ds_read_b128 a[16:19], v44 offset:6144
v_mfma_f32_16x16x32_bf16 v[96:99], a[72:75], a[48:51], v[96:99]
s_add_u32 s76, s76, 14336
ds_read_b64_tr_b16 a[28:29], v48 offset:1024
v_mfma_f32_16x16x32_bf16 v[100:103], a[72:75], a[52:55], v[100:103]
v_mfma_f32_16x16x32_bf16 v[104:107], a[72:75], a[56:59], v[104:107]
s_cmp_eq_u32 s76, s79
s_cselect_b32 s76, s78, s76
s_lshl_b32 s66, s83, 12
v_mfma_f32_16x16x32_bf16 v[108:111], a[72:75], a[60:63], v[108:111]
ds_read_b64_tr_b16 a[30:31], v48 offset:1536
s_add_u32 s6, s66, 4096
v_mfma_f32_16x16x32_bf16 v[152:155], a[84:87], a[44:47], v[152:155]
ds_read_b64_tr_b16 a[32:33], v49 offset:1024
s_add_u32 m0, s85, 139264
v_mfma_f32_16x16x32_bf16 v[156:159], a[84:87], a[48:51], v[156:159]
s_cmp_eq_u32 s6, 28672
s_cselect_b32 s6, 0, s6
s_add_u32 s7, s6, 4096
v_mfma_f32_16x16x32_bf16 v[160:163], a[84:87], a[52:55], v[160:163]
ds_read_b64_tr_b16 a[34:35], v49 offset:1536
buffer_load_dwordx4 v12, s[36:39], s76 offen offset:0 lds
v_mfma_f32_16x16x32_bf16 v[164:167], a[84:87], a[56:59], v[164:167]
ds_read_b64_tr_b16 a[36:37], v48 offset:2048
v_mfma_f32_16x16x32_bf16 v[168:171], a[84:87], a[60:63], v[168:171]
ds_read_b64_tr_b16 a[38:39], v48 offset:2560
buffer_load_dwordx4 v13, s[36:39], s76 offen offset:1024 lds
v_mfma_f32_16x16x32_bf16 v[132:135], a[80:83], a[44:47], v[132:135]
s_cmp_eq_u32 s7, 28672
s_cselect_b32 s7, 0, s7
s_add_u32 s8, s7, 4096
v_mfma_f32_16x16x32_bf16 v[136:139], a[80:83], a[48:51], v[136:139]
ds_read_b64_tr_b16 a[40:41], v49 offset:2048
s_add_u32 s76, s76, 14336
v_mfma_f32_16x16x32_bf16 v[140:143], a[80:83], a[52:55], v[140:143]
ds_read_b64_tr_b16 a[42:43], v49 offset:2560
v_mfma_f32_16x16x32_bf16 v[144:147], a[80:83], a[56:59], v[144:147]
s_cmp_eq_u32 s8, 28672
s_cselect_b32 s8, 0, s8
s_add_u32 s9, s8, 4096
v_mfma_f32_16x16x32_bf16 v[148:151], a[80:83], a[60:63], v[148:151]
ds_read_b64_tr_b16 a[20:21], v48 offset:0
s_add_u32 m0, s85, 147456
v_mfma_f32_16x16x32_bf16 v[72:75], a[68:71], a[44:47], v[72:75]
ds_read_b64_tr_b16 a[22:23], v48 offset:512
buffer_load_dwordx4 v12, s[36:39], s76 offen offset:0 lds
s_cmp_eq_u32 s9, 28672
s_cselect_b32 s9, 0, s9
v_mfma_f32_16x16x32_bf16 v[76:79], a[68:71], a[48:51], v[76:79]
ds_read_b64_tr_b16 a[24:25], v49 offset:0
s_add_u32 s10, s9, 4096
v_mfma_f32_16x16x32_bf16 v[80:83], a[68:71], a[52:55], v[80:83]
s_cmp_eq_u32 s10, 28672
s_cselect_b32 s10, 0, s10
s_add_u32 s11, s10, 4096
v_mfma_f32_16x16x32_bf16 v[84:87], a[68:71], a[56:59], v[84:87]
ds_read_b64_tr_b16 a[26:27], v49 offset:512
buffer_load_dwordx4 v13, s[36:39], s76 offen offset:1024 lds
v_mfma_f32_16x16x32_bf16 v[88:91], a[68:71], a[60:63], v[88:91]
s_cmp_eq_u32 s11, 28672
s_cselect_b32 s11, 0, s11
s_lshl_b32 s12, s82, 12
v_mfma_f32_16x16x32_bf16 v[52:55], a[64:67], a[44:47], v[52:55]
s_add_u32 s13, s12, 4096
s_and_b32 s13, s13, 0x3fff
s_add_u32 s14, s13, 4096
v_mfma_f32_16x16x32_bf16 v[56:59], a[64:67], a[48:51], v[56:59]
s_and_b32 s14, s14, 0x3fff
s_add_u32 s76, s76, 14336
s_add_u32 s15, s14, 4096
v_mfma_f32_16x16x32_bf16 v[60:63], a[64:67], a[52:55], v[60:63]
s_and_b32 s15, s15, 0x3fff
s_cmp_eq_u32 s76, s79
PADQ2:
s_cbranch_execz BACK_Q
s_cselect_b32 s76, s78, s76
v_mfma_f32_16x16x32_bf16 v[64:67], a[64:67], a[56:59], v[64:67]
v_mfma_f32_16x16x32_bf16 v[68:71], a[64:67], a[60:63], v[68:71]
s_waitcnt vmcnt(16) lgkmcnt(0)
s_barrier
v_mfma_f32_16x16x32_bf16 v[112:115], a[32:35], a[0:3], v[112:115]
ds_read_b128 a[44:47], v47 offset:0
s_add_u32 m0, s85, 24576
v_mfma_f32_16x16x32_bf16 v[116:119], a[32:35], a[4:7], v[116:119]
ds_read_b128 a[48:51], v45 offset:0
v_mfma_f32_16x16x32_bf16 v[120:123], a[32:35], a[8:11], v[120:123]
buffer_load_dwordx4 v12, s[36:39], s76 offen offset:0 lds
ds_read_b128 a[52:55], v45 offset:2048
v_mfma_f32_16x16x32_bf16 v[124:127], a[32:35], a[12:15], v[124:127]
ds_read_b128 a[56:59], v45 offset:4096
v_mfma_f32_16x16x32_bf16 v[128:131], a[32:35], a[16:19], v[128:131]
buffer_load_dwordx4 v13, s[36:39], s76 offen offset:1024 lds
v_mfma_f32_16x16x32_bf16 v[92:95], a[28:31], a[0:3], v[92:95]
ds_read_b128 a[60:63], v45 offset:6144
v_mfma_f32_16x16x32_bf16 v[96:99], a[28:31], a[4:7], v[96:99]
s_add_u32 s76, s76, 14336
ds_read_b64_tr_b16 a[72:73], v48 offset:13312
v_mfma_f32_16x16x32_bf16 v[100:103], a[28:31], a[8:11], v[100:103]
v_mfma_f32_16x16x32_bf16 v[104:107], a[28:31], a[12:15], v[104:107]
ds_read_b64_tr_b16 a[74:75], v48 offset:13824
s_waitcnt vmcnt(6)
v_mfma_f32_16x16x32_bf16 v[108:111], a[28:31], a[16:19], v[108:111]
s_add_u32 m0, s85, 81920
ds_read_b64_tr_b16 a[76:77], v49 offset:13312
v_mfma_f32_16x16x32_bf16 v[152:155], a[40:43], a[0:3], v[152:155]
ds_read_b64_tr_b16 a[160:161], v16 offset:40960
v_mfma_f32_16x16x32_bf16 v[156:159], a[40:43], a[4:7], v[156:159]
ds_read_b64_tr_b16 a[162:163], v16 offset:41472
buffer_load_dwordx4 v12, s[36:39], s76 offen offset:0 lds
v_mfma_f32_16x16x32_bf16 v[160:163], a[40:43], a[8:11], v[160:163]
ds_read_b64_tr_b16 a[78:79], v49 offset:13824
v_mfma_f32_16x16x32_bf16 v[164:167], a[40:43], a[12:15], v[164:167]
ds_read_b64_tr_b16 a[164:165], v17 offset:40960
buffer_load_dwordx4 v13, s[36:39], s76 offen offset:1024 lds
v_mfma_f32_16x16x32_bf16 v[168:171], a[40:43], a[16:19], v[168:171]
ds_read_b64_tr_b16 a[80:81], v48 offset:14336
v_mfma_f32_16x16x32_bf16 v[132:135], a[36:39], a[0:3], v[132:135]
ds_read_b64_tr_b16 a[166:167], v17 offset:41472
s_add_u32 s76, s76, 14336
v_mfma_f32_16x16x32_bf16 v[136:139], a[36:39], a[4:7], v[136:139]
ds_read_b64_tr_b16 a[82:83], v48 offset:14848
v_mfma_f32_16x16x32_bf16 v[140:143], a[36:39], a[8:11], v[140:143]
ds_read_b64_tr_b16 a[168:169], v16 offset:49152
v_mfma_f32_16x16x32_bf16 v[144:147], a[36:39], a[12:15], v[144:147]
ds_read_b64_tr_b16 a[170:171], v16 offset:49664
v_mfma_f32_16x16x32_bf16 v[148:151], a[36:39], a[16:19], v[148:151]
ds_read_b64_tr_b16 a[84:85], v49 offset:14336
v_mfma_f32_16x16x32_bf16 v[72:75], a[24:27], a[0:3], v[72:75]
ds_read_b64_tr_b16 a[172:173], v17 offset:49152
v_mfma_f32_16x16x32_bf16 v[76:79], a[24:27], a[4:7], v[76:79]
ds_read_b64_tr_b16 a[86:87], v49 offset:14848
ds_read_b64_tr_b16 a[174:175], v17 offset:49664
v_mfma_f32_16x16x32_bf16 v[80:83], a[24:27], a[8:11], v[80:83]
ds_read_b64_tr_b16 a[64:65], v48 offset:12288
s_cmp_eq_u32 s76, s79
s_cselect_b32 s76, s78, s76
v_mfma_f32_16x16x32_bf16 v[84:87], a[24:27], a[12:15], v[84:87]
ds_read_b64_tr_b16 a[176:177], v16 offset:57344
s_add_u32 m0, s85, 32768
v_mfma_f32_16x16x32_bf16 v[88:91], a[24:27], a[16:19], v[88:91]
ds_read_b64_tr_b16 a[178:179], v16 offset:57856
buffer_load_dwordx4 v12, s[36:39], s76 offen offset:0 lds
ds_read_b64_tr_b16 a[66:67], v48 offset:12800
v_mfma_f32_16x16x32_bf16 v[52:55], a[20:23], a[0:3], v[52:55]
ds_read_b64_tr_b16 a[180:181], v17 offset:57344
buffer_load_dwordx4 v13, s[36:39], s76 offen offset:1024 lds
ds_read_b64_tr_b16 a[68:69], v49 offset:12288
v_mfma_f32_16x16x32_bf16 v[56:59], a[20:23], a[4:7], v[56:59]
ds_read_b64_tr_b16 a[182:183], v17 offset:57856
s_add_u32 s76, s76, 14336
v_mfma_f32_16x16x32_bf16 v[60:63], a[20:23], a[8:11], v[60:63]
ds_read_b64_tr_b16 a[70:71], v49 offset:12800
ds_read_b64_tr_b16 a[184:185], v18 offset:0
v_mfma_f32_16x16x32_bf16 v[64:67], a[20:23], a[12:15], v[64:67]
ds_read_b64_tr_b16 a[186:187], v18 offset:512
v_mfma_f32_16x16x32_bf16 v[68:71], a[20:23], a[16:19], v[68:71]
ds_read_b64_tr_b16 a[188:189], v19 offset:0
ds_read_b64_tr_b16 a[190:191], v19 offset:512
s_waitcnt vmcnt(10) lgkmcnt(0)
s_barrier
v_mfma_f32_16x16x32_bf16 v[112:115], a[76:79], a[44:47], v[112:115]
s_add_u32 m0, s85, 40960
s_waitcnt vmcnt(12)
v_mfma_f32_16x16x32_bf16 v[116:119], a[76:79], a[48:51], v[116:119]
v_xor_b32 v8, s86, v173
v_mfma_f32_16x16x32_bf16 v[120:123], a[76:79], a[52:55], v[120:123]
v_bitop3_b32 v8, v175, s86, v8 bitop3:0xbe
v_bitop3_b32 v8, v177, s86, v8 bitop3:0xbe
v_mfma_f32_16x16x32_bf16 v[124:127], a[76:79], a[56:59], v[124:127]
buffer_load_dwordx4 v12, s[36:39], s76 offen offset:0 lds
v_bitop3_b32 v8, v179, s86, v8 bitop3:0xbe
v_mfma_f32_16x16x32_bf16 v[128:131], a[76:79], a[60:63], v[128:131]
v_bitop3_b32 v8, v181, s86, v8 bitop3:0xbe
v_bitop3_b32 v8, v183, s86, v8 bitop3:0xbe
v_mfma_f32_16x16x32_bf16 v[92:95], a[72:75], a[44:47], v[92:95]
buffer_load_dwordx4 v13, s[36:39], s76 offen offset:1024 lds
v_bitop3_b32 v8, v205, s86, v8 bitop3:0xbe
v_mfma_f32_16x16x32_bf16 v[96:99], a[72:75], a[48:51], v[96:99]
v_bitop3_b32 v8, v207, s86, v8 bitop3:0xbe
s_add_u32 s76, s76, 14336
v_mfma_f32_16x16x32_bf16 v[100:103], a[72:75], a[52:55], v[100:103]
v_bitop3_b32 v8, v209, s86, v8 bitop3:0xbe
v_bitop3_b32 v8, v211, s86, v8 bitop3:0xbe
v_mfma_f32_16x16x32_bf16 v[104:107], a[72:75], a[56:59], v[104:107]
v_bitop3_b32 v8, v213, s86, v8 bitop3:0xbe
v_bitop3_b32 v8, v215, s86, v8 bitop3:0xbe
v_mfma_f32_16x16x32_bf16 v[108:111], a[72:75], a[60:63], v[108:111]
ds_read_b64_tr_b16 a[192:193], v22 offset:40960
v_bitop3_b32 v8, v217, s86, v8 bitop3:0xbe
v_mfma_f32_16x16x32_bf16 v[152:155], a[84:87], a[44:47], v[152:155]
ds_read_b64_tr_b16 a[194:195], v22 offset:41472
v_bitop3_b32 v8, v219, s86, v8 bitop3:0xbe
v_mfma_f32_16x16x32_bf16 v[156:159], a[84:87], a[48:51], v[156:159]
ds_read_b64_tr_b16 a[196:197], v23 offset:40960
v_cmp_ne_u32 vcc, 0, v8
v_mfma_f32_16x16x32_bf16 v[160:163], a[84:87], a[52:55], v[160:163]
ds_read_b64_tr_b16 a[198:199], v23 offset:41472
v_mfma_f32_16x16x32_bf16 v[164:167], a[84:87], a[56:59], v[164:167]
s_cmp_eq_u32 s76, s79
s_cselect_b32 s76, s78, s76
s_add_u32 m0, s85, 90112
v_mfma_f32_16x16x32_bf16 v[168:171], a[84:87], a[60:63], v[168:171]
buffer_load_dwordx4 v12, s[36:39], s76 offen offset:0 lds
ds_read_b64_tr_b16 a[200:201], v22 offset:49152
v_mfma_f32_16x16x32_bf16 v[132:135], a[80:83], a[44:47], v[132:135]
ds_read_b64_tr_b16 a[202:203], v22 offset:49664
buffer_load_dwordx4 v13, s[36:39], s76 offen offset:1024 lds
s_cmp_lg_u64 vcc, 0
s_cbranch_scc1 GQ_S
GQ_X:
v_mfma_f32_16x16x32_bf16 v[136:139], a[80:83], a[48:51], v[136:139]
ds_read_b64_tr_b16 a[204:205], v23 offset:49152
v_add_f32 v172, v172, v176
v_add_f32 v180, v180, v204
v_mfma_f32_16x16x32_bf16 v[140:143], a[80:83], a[52:55], v[140:143]
ds_read_b64_tr_b16 a[206:207], v23 offset:49664
s_add_u32 s76, s76, 14336
v_add_f32 v208, v208, v212
v_mfma_f32_16x16x32_bf16 v[144:147], a[80:83], a[56:59], v[144:147]
ds_read_b64_tr_b16 a[208:209], v22 offset:57344
v_add_f32 v172, v172, v180
v_add_f32 v208, v208, v216
v_mfma_f32_16x16x32_bf16 v[148:151], a[80:83], a[60:63], v[148:151]
ds_read_b64_tr_b16 a[210:211], v22 offset:57856
s_add_u32 m0, s85, 98304
v_add_f32 v4, v172, v208
v_mfma_f32_16x16x32_bf16 v[72:75], a[68:71], a[44:47], v[72:75]
ds_read_b64_tr_b16 a[212:213], v23 offset:57344
v_add_f32 v174, v174, v178
v_add_f32 v182, v182, v206
v_mfma_f32_16x16x32_bf16 v[76:79], a[68:71], a[48:51], v[76:79]
buffer_load_dwordx4 v12, s[36:39], s76 offen offset:0 lds
ds_read_b64_tr_b16 a[214:215], v23 offset:57856
v_add_f32 v210, v210, v214
v_add_f32 v174, v174, v182
v_mfma_f32_16x16x32_bf16 v[80:83], a[68:71], a[52:55], v[80:83]
v_add_f32 v210, v210, v218
v_add_f32 v5, v174, v210
v_mfma_f32_16x16x32_bf16 v[84:87], a[68:71], a[56:59], v[84:87]
ds_read_b64_tr_b16 a[216:217], v24 offset:0
buffer_load_dwordx4 v13, s[36:39], s76 offen offset:1024 lds
v_mov_b32 v6, v4
v_mfma_f32_16x16x32_bf16 v[88:91], a[68:71], a[60:63], v[88:91]
ds_read_b64_tr_b16 a[218:219], v24 offset:512
v_mov_b32 v7, v5
v_mfma_f32_16x16x32_bf16 v[52:55], a[64:67], a[44:47], v[52:55]
ds_bpermute_b32 v228, v220, v112
s_add_u32 s76, s76, 14336
ds_bpermute_b32 v230, v220, v116
v_mfma_f32_16x16x32_bf16 v[56:59], a[64:67], a[48:51], v[56:59]
ds_read_b64_tr_b16 a[220:221], v25 offset:0
v_permlane16_swap_b32 v4, v6
v_permlane16_swap_b32 v5, v7
v_mfma_f32_16x16x32_bf16 v[60:63], a[64:67], a[52:55], v[60:63]
ds_read_b64_tr_b16 a[222:223], v25 offset:512
v_mov_b32 v172, v4
v_mfma_f32_16x16x32_bf16 v[64:67], a[64:67], a[56:59], v[64:67]
s_cmp_eq_u32 s76, s79
s_cselect_b32 s76, s78, s76
v_mov_b32 v173, v6
v_mov_b32 v3, v5
v_mfma_f32_16x16x32_bf16 v[68:71], a[64:67], a[60:63], v[68:71]
v_mov_b32 v174, v7
ds_bpermute_b32 v232, v220, v120
ds_bpermute_b32 v234, v220, v124
ds_bpermute_b32 v236, v220, v128
v_permlane32_swap_b32 v4, v172
v_permlane32_swap_b32 v6, v173
v_permlane32_swap_b32 v5, v3
v_permlane32_swap_b32 v7, v174
v_mov_b32_dpp v208, v112 row_newbcast:0 row_mask:0xf bank_mask:0xf
v_mov_b32_dpp v209, v113 row_newbcast:0 row_mask:0xf bank_mask:0xf
v_mov_b32_dpp v210, v114 row_newbcast:0 row_mask:0xf bank_mask:0xf
v_mov_b32_dpp v211, v115 row_newbcast:0 row_mask:0xf bank_mask:0xf
v_mov_b32_dpp v204, v92 row_newbcast:0 row_mask:0xf bank_mask:0xf
v_mov_b32_dpp v205, v93 row_newbcast:0 row_mask:0xf bank_mask:0xf
v_mov_b32_dpp v206, v94 row_newbcast:0 row_mask:0xf bank_mask:0xf
v_mov_b32_dpp v207, v95 row_newbcast:0 row_mask:0xf bank_mask:0xf
v_mov_b32_dpp v216, v152 row_newbcast:0 row_mask:0xf bank_mask:0xf
v_mov_b32_dpp v217, v153 row_newbcast:0 row_mask:0xf bank_mask:0xf
v_mov_b32_dpp v218, v154 row_newbcast:0 row_mask:0xf bank_mask:0xf
v_mov_b32_dpp v219, v155 row_newbcast:0 row_mask:0xf bank_mask:0xf
v_mov_b32_dpp v212, v132 row_newbcast:0 row_mask:0xf bank_mask:0xf
v_mov_b32_dpp v213, v133 row_newbcast:0 row_mask:0xf bank_mask:0xf
v_mov_b32_dpp v214, v134 row_newbcast:0 row_mask:0xf bank_mask:0xf
v_mov_b32_dpp v215, v135 row_newbcast:0 row_mask:0xf bank_mask:0xf
s_waitcnt lgkmcnt(0)
s_barrier
s_mov_b32 s63, 0x3b124925
v_mul_f32 v228, 0xbb124925, v228
v_mul_f32 v230, 0xbb124925, v230
v_mul_f32 v232, 0xbb124925, v232
v_mul_f32 v234, 0xbb124925, v234
v_mul_f32 v236, 0xbb124925, v236
v_mul_f32 v229, v228, v228
v_mul_f32 v231, v230, v230
v_mul_f32 v233, v232, v232
v_mul_f32 v235, v234, v234
v_mul_f32 v237, v236, v236
s_nop 0
v_fma_f32 v229, v3, s63, -v229
v_fma_f32 v231, v4, s63, -v231
v_fma_f32 v233, v5, s63, -v233
v_fma_f32 v235, v6, s63, -v235
v_fma_f32 v237, v7, s63, -v237
v_max_f32 v229, 0, v229
v_max_f32 v231, 0, v231
v_max_f32 v233, 0, v233
v_max_f32 v235, 0, v235
v_max_f32 v237, 0, v237
s_nop 0
v_add_f32 v229, 0x3727c5ac, v229
v_add_f32 v231, 0x3727c5ac, v231
v_add_f32 v233, 0x3727c5ac, v233
v_add_f32 v235, 0x3727c5ac, v235
v_add_f32 v237, 0x3727c5ac, v237
v_rsq_f32 v229, v229
v_rsq_f32 v231, v231
v_rsq_f32 v233, v233
v_rsq_f32 v235, v235
v_rsq_f32 v237, v237
s_nop 0
v_mov_b32_dpp v72, v72 row_newbcast:0 row_mask:0xf bank_mask:0xf
v_mov_b32_dpp v73, v73 row_newbcast:0 row_mask:0xf bank_mask:0xf
v_mov_b32_dpp v74, v74 row_newbcast:0 row_mask:0xf bank_mask:0xf
v_mov_b32_dpp v75, v75 row_newbcast:0 row_mask:0xf bank_mask:0xf
v_mov_b32_dpp v52, v52 row_newbcast:0 row_mask:0xf bank_mask:0xf
v_mov_b32_dpp v53, v53 row_newbcast:0 row_mask:0xf bank_mask:0xf
v_mov_b32_dpp v54, v54 row_newbcast:0 row_mask:0xf bank_mask:0xf
v_mov_b32_dpp v55, v55 row_newbcast:0 row_mask:0xf bank_mask:0xf
v_pk_fma_f32 v[132:133], v[212:213], v[228:229], v[132:133] op_sel_hi:[1,0,1]
v_pk_fma_f32 v[134:135], v[214:215], v[228:229], v[134:135] op_sel_hi:[1,0,1]
v_pk_fma_f32 v[152:153], v[216:217], v[228:229], v[152:153] op_sel_hi:[1,0,1]
v_pk_fma_f32 v[154:155], v[218:219], v[228:229], v[154:155] op_sel_hi:[1,0,1]
v_pk_mul_f32 v[132:133], v[132:133], v[228:229] op_sel:[0,1] op_sel_hi:[1,1]
v_pk_mul_f32 v[134:135], v[134:135], v[228:229] op_sel:[0,1] op_sel_hi:[1,1]
v_pk_mul_f32 v[152:153], v[152:153], v[228:229] op_sel:[0,1] op_sel_hi:[1,1]
v_pk_mul_f32 v[154:155], v[154:155], v[228:229] op_sel:[0,1] op_sel_hi:[1,1]
v_cvt_pk_bf16_f32 v132, v132, v133
v_cvt_pk_bf16_f32 v133, v134, v135
v_cvt_pk_bf16_f32 v134, v152, v153
v_cvt_pk_bf16_f32 v135, v154, v155
ds_write_b128 v222, v[132:135] offset:0
v_pk_fma_f32 v[136:137], v[212:213], v[230:231], v[136:137] op_sel_hi:[1,0,1]
v_pk_fma_f32 v[138:139], v[214:215], v[230:231], v[138:139] op_sel_hi:[1,0,1]
v_pk_fma_f32 v[156:157], v[216:217], v[230:231], v[156:157] op_sel_hi:[1,0,1]
v_pk_fma_f32 v[158:159], v[218:219], v[230:231], v[158:159] op_sel_hi:[1,0,1]
v_pk_mul_f32 v[136:137], v[136:137], v[230:231] op_sel:[0,1] op_sel_hi:[1,1]
v_pk_mul_f32 v[138:139], v[138:139], v[230:231] op_sel:[0,1] op_sel_hi:[1,1]
v_pk_mul_f32 v[156:157], v[156:157], v[230:231] op_sel:[0,1] op_sel_hi:[1,1]
v_pk_mul_f32 v[158:159], v[158:159], v[230:231] op_sel:[0,1] op_sel_hi:[1,1]
v_cvt_pk_bf16_f32 v136, v136, v137
v_cvt_pk_bf16_f32 v137, v138, v139
v_cvt_pk_bf16_f32 v138, v156, v157
v_cvt_pk_bf16_f32 v139, v158, v159
ds_write_b128 v222, v[136:139] offset:8192
v_pk_fma_f32 v[140:141], v[212:213], v[232:233], v[140:141] op_sel_hi:[1,0,1]
v_pk_fma_f32 v[142:143], v[214:215], v[232:233], v[142:143] op_sel_hi:[1,0,1]
v_pk_fma_f32 v[160:161], v[216:217], v[232:233], v[160:161] op_sel_hi:[1,0,1]
v_pk_fma_f32 v[162:163], v[218:219], v[232:233], v[162:163] op_sel_hi:[1,0,1]
v_pk_mul_f32 v[140:141], v[140:141], v[232:233] op_sel:[0,1] op_sel_hi:[1,1]
v_pk_mul_f32 v[142:143], v[142:143], v[232:233] op_sel:[0,1] op_sel_hi:[1,1]
v_pk_mul_f32 v[160:161], v[160:161], v[232:233] op_sel:[0,1] op_sel_hi:[1,1]
v_pk_mul_f32 v[162:163], v[162:163], v[232:233] op_sel:[0,1] op_sel_hi:[1,1]
v_cvt_pk_bf16_f32 v140, v140, v141
v_cvt_pk_bf16_f32 v141, v142, v143
v_cvt_pk_bf16_f32 v142, v160, v161
v_cvt_pk_bf16_f32 v143, v162, v163
ds_write_b128 v222, v[140:143] offset:16384
v_pk_fma_f32 v[144:145], v[212:213], v[234:235], v[144:145] op_sel_hi:[1,0,1]
v_pk_fma_f32 v[146:147], v[214:215], v[234:235], v[146:147] op_sel_hi:[1,0,1]
v_pk_fma_f32 v[164:165], v[216:217], v[234:235], v[164:165] op_sel_hi:[1,0,1]
v_pk_fma_f32 v[166:167], v[218:219], v[234:235], v[166:167] op_sel_hi:[1,0,1]
v_pk_mul_f32 v[144:145], v[144:145], v[234:235] op_sel:[0,1] op_sel_hi:[1,1]
v_pk_mul_f32 v[146:147], v[146:147], v[234:235] op_sel:[0,1] op_sel_hi:[1,1]
v_pk_mul_f32 v[164:165], v[164:165], v[234:235] op_sel:[0,1] op_sel_hi:[1,1]
v_pk_mul_f32 v[166:167], v[166:167], v[234:235] op_sel:[0,1] op_sel_hi:[1,1]
v_cvt_pk_bf16_f32 v144, v144, v145
v_cvt_pk_bf16_f32 v145, v146, v147
v_cvt_pk_bf16_f32 v146, v164, v165
v_cvt_pk_bf16_f32 v147, v166, v167
ds_write_b128 v226, v[144:147] offset:0
v_pk_fma_f32 v[148:149], v[212:213], v[236:237], v[148:149] op_sel_hi:[1,0,1]
v_pk_fma_f32 v[150:151], v[214:215], v[236:237], v[150:151] op_sel_hi:[1,0,1]
v_pk_fma_f32 v[168:169], v[216:217], v[236:237], v[168:169] op_sel_hi:[1,0,1]
v_pk_fma_f32 v[170:171], v[218:219], v[236:237], v[170:171] op_sel_hi:[1,0,1]
v_pk_mul_f32 v[148:149], v[148:149], v[236:237] op_sel:[0,1] op_sel_hi:[1,1]
v_pk_mul_f32 v[150:151], v[150:151], v[236:237] op_sel:[0,1] op_sel_hi:[1,1]
v_pk_mul_f32 v[168:169], v[168:169], v[236:237] op_sel:[0,1] op_sel_hi:[1,1]
v_pk_mul_f32 v[170:171], v[170:171], v[236:237] op_sel:[0,1] op_sel_hi:[1,1]
v_cvt_pk_bf16_f32 v148, v148, v149
v_cvt_pk_bf16_f32 v149, v150, v151
v_cvt_pk_bf16_f32 v150, v168, v169
v_cvt_pk_bf16_f32 v151, v170, v171
ds_write_b128 v226, v[148:151] offset:8192
s_add_u32 m0, s85, 49152
s_nop 0
buffer_load_dwordx4 v12, s[36:39], s76 offen offset:0 lds
buffer_load_dwordx4 v13, s[36:39], s76 offen offset:1024 lds
s_add_u32 s76, s76, 14336
s_nop 0
v_pk_fma_f32 v[92:93], v[204:205], v[228:229], v[92:93] op_sel_hi:[1,0,1]
v_pk_fma_f32 v[94:95], v[206:207], v[228:229], v[94:95] op_sel_hi:[1,0,1]
v_pk_fma_f32 v[112:113], v[208:209], v[228:229], v[112:113] op_sel_hi:[1,0,1]
v_pk_fma_f32 v[114:115], v[210:211], v[228:229], v[114:115] op_sel_hi:[1,0,1]
v_pk_mul_f32 v[92:93], v[92:93], v[228:229] op_sel:[0,1] op_sel_hi:[1,1]
v_pk_mul_f32 v[94:95], v[94:95], v[228:229] op_sel:[0,1] op_sel_hi:[1,1]
v_pk_mul_f32 v[112:113], v[112:113], v[228:229] op_sel:[0,1] op_sel_hi:[1,1]
v_pk_mul_f32 v[114:115], v[114:115], v[228:229] op_sel:[0,1] op_sel_hi:[1,1]
v_cvt_pk_bf16_f32 v92, v92, v93
v_cvt_pk_bf16_f32 v93, v94, v95
v_cvt_pk_bf16_f32 v94, v112, v113
v_cvt_pk_bf16_f32 v95, v114, v115
ds_read_b64_tr_b16 a[76:77], v223 offset:0
ds_read_b64_tr_b16 a[86:87], v223 offset:8
v_pk_fma_f32 v[96:97], v[204:205], v[230:231], v[96:97] op_sel_hi:[1,0,1]
v_pk_fma_f32 v[98:99], v[206:207], v[230:231], v[98:99] op_sel_hi:[1,0,1]
v_pk_fma_f32 v[116:117], v[208:209], v[230:231], v[116:117] op_sel_hi:[1,0,1]
v_pk_fma_f32 v[118:119], v[210:211], v[230:231], v[118:119] op_sel_hi:[1,0,1]
v_pk_mul_f32 v[96:97], v[96:97], v[230:231] op_sel:[0,1] op_sel_hi:[1,1]
v_pk_mul_f32 v[98:99], v[98:99], v[230:231] op_sel:[0,1] op_sel_hi:[1,1]
v_pk_mul_f32 v[116:117], v[116:117], v[230:231] op_sel:[0,1] op_sel_hi:[1,1]
v_pk_mul_f32 v[118:119], v[118:119], v[230:231] op_sel:[0,1] op_sel_hi:[1,1]
v_cvt_pk_bf16_f32 v96, v96, v97
v_cvt_pk_bf16_f32 v97, v98, v99
v_cvt_pk_bf16_f32 v98, v116, v117
v_cvt_pk_bf16_f32 v99, v118, v119
ds_read_b64_tr_b16 a[78:79], v223 offset:8192
ds_read_b64_tr_b16 a[88:89], v223 offset:8200
s_add_u32 m0, s85, 57344
s_nop 0
buffer_load_dwordx4 v12, s[36:39], s76 offen offset:0 lds
buffer_load_dwordx4 v13, s[36:39], s76 offen offset:1024 lds
s_add_u32 s76, s76, 14336
s_cmp_eq_u32 s76, s79
s_cselect_b32 s76, s78, s76
s_nop 0
v_pk_fma_f32 v[100:101], v[204:205], v[232:233], v[100:101] op_sel_hi:[1,0,1]
v_pk_fma_f32 v[102:103], v[206:207], v[232:233], v[102:103] op_sel_hi:[1,0,1]
v_pk_fma_f32 v[120:121], v[208:209], v[232:233], v[120:121] op_sel_hi:[1,0,1]
v_pk_fma_f32 v[122:123], v[210:211], v[232:233], v[122:123] op_sel_hi:[1,0,1]
v_pk_mul_f32 v[100:101], v[100:101], v[232:233] op_sel:[0,1] op_sel_hi:[1,1]
v_pk_mul_f32 v[102:103], v[102:103], v[232:233] op_sel:[0,1] op_sel_hi:[1,1]
v_pk_mul_f32 v[120:121], v[120:121], v[232:233] op_sel:[0,1] op_sel_hi:[1,1]
v_pk_mul_f32 v[122:123], v[122:123], v[232:233] op_sel:[0,1] op_sel_hi:[1,1]
v_cvt_pk_bf16_f32 v100, v100, v101
v_cvt_pk_bf16_f32 v101, v102, v103
v_cvt_pk_bf16_f32 v102, v120, v121
v_cvt_pk_bf16_f32 v103, v122, v123
ds_read_b64_tr_b16 a[80:81], v223 offset:16384
ds_read_b64_tr_b16 a[90:91], v223 offset:16392
s_add_u32 m0, s85, 106496
s_nop 0
buffer_load_dwordx4 v12, s[40:43], s77 offen offset:0 lds
buffer_load_dwordx4 v13, s[40:43], s77 offen offset:1024 lds
s_add_u32 s77, s77, 14336
s_nop 0
v_pk_fma_f32 v[104:105], v[204:205], v[234:235], v[104:105] op_sel_hi:[1,0,1]
v_pk_fma_f32 v[106:107], v[206:207], v[234:235], v[106:107] op_sel_hi:[1,0,1]
v_pk_fma_f32 v[124:125], v[208:209], v[234:235], v[124:125] op_sel_hi:[1,0,1]
v_pk_fma_f32 v[126:127], v[210:211], v[234:235], v[126:127] op_sel_hi:[1,0,1]
v_pk_mul_f32 v[104:105], v[104:105], v[234:235] op_sel:[0,1] op_sel_hi:[1,1]
v_pk_mul_f32 v[106:107], v[106:107], v[234:235] op_sel:[0,1] op_sel_hi:[1,1]
v_pk_mul_f32 v[124:125], v[124:125], v[234:235] op_sel:[0,1] op_sel_hi:[1,1]
v_pk_mul_f32 v[126:127], v[126:127], v[234:235] op_sel:[0,1] op_sel_hi:[1,1]
v_cvt_pk_bf16_f32 v104, v104, v105
v_cvt_pk_bf16_f32 v105, v106, v107
v_cvt_pk_bf16_f32 v106, v124, v125
v_cvt_pk_bf16_f32 v107, v126, v127
ds_read_b64_tr_b16 a[82:83], v227 offset:0
ds_read_b64_tr_b16 a[92:93], v227 offset:8
s_add_u32 m0, s85, 114688
s_nop 0
buffer_load_dwordx4 v12, s[40:43], s77 offen offset:0 lds
buffer_load_dwordx4 v13, s[40:43], s77 offen offset:1024 lds
s_add_u32 s77, s77, 10752
s_cmp_eq_u32 s77, s81
s_cselect_b32 s77, s80, s77
s_nop 0
v_pk_fma_f32 v[108:109], v[204:205], v[236:237], v[108:109] op_sel_hi:[1,0,1]
v_pk_fma_f32 v[110:111], v[206:207], v[236:237], v[110:111] op_sel_hi:[1,0,1]
v_pk_fma_f32 v[128:129], v[208:209], v[236:237], v[128:129] op_sel_hi:[1,0,1]
v_pk_fma_f32 v[130:131], v[210:211], v[236:237], v[130:131] op_sel_hi:[1,0,1]
v_pk_mul_f32 v[108:109], v[108:109], v[236:237] op_sel:[0,1] op_sel_hi:[1,1]
v_pk_mul_f32 v[110:111], v[110:111], v[236:237] op_sel:[0,1] op_sel_hi:[1,1]
v_pk_mul_f32 v[128:129], v[128:129], v[236:237] op_sel:[0,1] op_sel_hi:[1,1]
v_pk_mul_f32 v[130:131], v[130:131], v[236:237] op_sel:[0,1] op_sel_hi:[1,1]
v_cvt_pk_bf16_f32 v108, v108, v109
v_cvt_pk_bf16_f32 v109, v110, v111
v_cvt_pk_bf16_f32 v110, v128, v129
v_cvt_pk_bf16_f32 v111, v130, v131
ds_read_b64_tr_b16 a[84:85], v227 offset:8192
ds_read_b64_tr_b16 a[94:95], v227 offset:8200
s_add_u32 m0, s85, 122880
s_nop 0
buffer_load_dwordx4 v12, s[40:43], s77 offen offset:0 lds
buffer_load_dwordx4 v13, s[40:43], s77 offen offset:1024 lds
s_add_u32 s77, s77, 14336
s_nop 0
v_pk_fma_f32 v[56:57], v[52:53], v[230:231], v[56:57] op_sel_hi:[1,0,1]
v_pk_fma_f32 v[58:59], v[54:55], v[230:231], v[58:59] op_sel_hi:[1,0,1]
v_pk_fma_f32 v[76:77], v[72:73], v[230:231], v[76:77] op_sel_hi:[1,0,1]
v_pk_fma_f32 v[78:79], v[74:75], v[230:231], v[78:79] op_sel_hi:[1,0,1]
v_cvt_pk_bf16_f32 v56, v56, v57
v_cvt_pk_bf16_f32 v57, v58, v59
v_cvt_pk_bf16_f32 v58, v76, v77
v_cvt_pk_bf16_f32 v59, v78, v79
v_pk_fma_f32 v[60:61], v[52:53], v[232:233], v[60:61] op_sel_hi:[1,0,1]
v_pk_fma_f32 v[62:63], v[54:55], v[232:233], v[62:63] op_sel_hi:[1,0,1]
v_pk_fma_f32 v[80:81], v[72:73], v[232:233], v[80:81] op_sel_hi:[1,0,1]
v_pk_fma_f32 v[82:83], v[74:75], v[232:233], v[82:83] op_sel_hi:[1,0,1]
v_cvt_pk_bf16_f32 v60, v60, v61
v_cvt_pk_bf16_f32 v61, v62, v63
v_cvt_pk_bf16_f32 v62, v80, v81
v_cvt_pk_bf16_f32 v63, v82, v83
v_pk_fma_f32 v[64:65], v[52:53], v[234:235], v[64:65] op_sel_hi:[1,0,1]
v_pk_fma_f32 v[66:67], v[54:55], v[234:235], v[66:67] op_sel_hi:[1,0,1]
v_pk_fma_f32 v[84:85], v[72:73], v[234:235], v[84:85] op_sel_hi:[1,0,1]
v_pk_fma_f32 v[86:87], v[74:75], v[234:235], v[86:87] op_sel_hi:[1,0,1]
v_cvt_pk_bf16_f32 v64, v64, v65
v_cvt_pk_bf16_f32 v65, v66, v67
v_cvt_pk_bf16_f32 v66, v84, v85
v_cvt_pk_bf16_f32 v67, v86, v87
v_pk_fma_f32 v[68:69], v[52:53], v[236:237], v[68:69] op_sel_hi:[1,0,1]
v_pk_fma_f32 v[70:71], v[54:55], v[236:237], v[70:71] op_sel_hi:[1,0,1]
v_pk_fma_f32 v[88:89], v[72:73], v[236:237], v[88:89] op_sel_hi:[1,0,1]
v_pk_fma_f32 v[90:91], v[74:75], v[236:237], v[90:91] op_sel_hi:[1,0,1]
v_cvt_pk_bf16_f32 v68, v68, v69
v_cvt_pk_bf16_f32 v69, v70, v71
v_cvt_pk_bf16_f32 v70, v88, v89
v_cvt_pk_bf16_f32 v71, v90, v91
s_add_u32 m0, s85, 131072
s_nop 0
buffer_load_dwordx4 v12, s[40:43], s77 offen offset:0 lds
buffer_load_dwordx4 v13, s[40:43], s77 offen offset:1024 lds
s_add_u32 s77, s77, 10752
s_cmp_eq_u32 s77, s81
s_cselect_b32 s77, s80, s77
v_mfma_f32_16x16x32_bf16 v[116:119], v[92:95], v[56:59], v[192:195]
v_cmp_eq_u32 vcc, 1, v201
v_mfma_f32_16x16x32_bf16 v[156:159], v[96:99], v[56:59], v[188:191]
s_nop 0
v_cndmask_b32 v8, v231, v233, vcc
v_mfma_f32_16x16x32_bf16 v[120:123], v[96:99], v[60:63], v[184:187]
v_cmp_eq_u32 vcc, 2, v201
v_mfma_f32_16x16x32_bf16 v[160:163], v[100:103], v[60:63], v[188:191]
s_nop 0
v_cndmask_b32 v8, v8, v235, vcc
v_mfma_f32_16x16x32_bf16 v[124:127], v[100:103], v[64:67], v[184:187]
v_cmp_eq_u32 vcc, 3, v201
v_mfma_f32_16x16x32_bf16 v[164:167], v[104:107], v[64:67], v[188:191]
s_nop 0
v_cndmask_b32 v8, v8, v237, vcc
v_mfma_f32_16x16x32_bf16 v[128:131], v[104:107], v[68:71], v[184:187]
v_cmp_lt_u32 vcc, 31, v0
v_mfma_f32_16x16x32_bf16 v[168:171], v[108:111], v[68:71], v[188:191]
s_waitcnt lgkmcnt(0)
s_mov_b32 s24, s4
s_mov_b32 s25, s5
s_mov_b32 s26, 1835008
s_mov_b32 s64, 13312
s_add_u32 m0, s85, 155648
s_nop 0
buffer_load_dwordx4 v26, s[24:27], 0 offen offset:0 lds
buffer_load_dwordx4 v26, s[24:27], s64 offen offset:1024 lds
v_cndmask_b32 v176, v231, v233, vcc
s_add_u32 m0, s85, 0
v_cndmask_b32 v180, v235, v237, vcc
v_max_f32 v116, v116, v156
v_max_f32 v124, v124, v164
v_max_f32 v117, v117, v157
buffer_load_dwordx4 v12, s[40:43], s77 offen offset:0 lds
v_max_f32 v125, v125, v165
v_max_f32 v118, v118, v158
v_max_f32 v126, v126, v166
v_max_f32 v119, v119, v159
buffer_load_dwordx4 v13, s[40:43], s77 offen offset:1024 lds
v_max_f32 v127, v127, v167
v_max_f32 v120, v120, v160
v_max_f32 v128, v128, v168
v_max_f32 v121, v121, v161
s_add_u32 s77, s77, 14336
v_max_f32 v129, v129, v169
v_max_f32 v122, v122, v162
v_max_f32 v130, v130, v170
v_max_f32 v123, v123, v163
s_add_u32 m0, s85, 8192
v_max_f32 v131, v131, v171
v_mul_f32 v176, 0x3e8b97f6, v176
v_mul_f32 v180, 0x3e8b97f6, v180
v_permlane32_swap_b32 v116, v120
buffer_load_dwordx4 v12, s[40:43], s77 offen offset:0 lds
v_permlane32_swap_b32 v124, v128
v_permlane32_swap_b32 v117, v121
v_permlane32_swap_b32 v125, v129
v_permlane32_swap_b32 v118, v122
buffer_load_dwordx4 v13, s[40:43], s77 offen offset:1024 lds
v_permlane32_swap_b32 v126, v130
v_permlane32_swap_b32 v119, v123
v_permlane32_swap_b32 v127, v131
v_max_f32 v116, v116, v120
s_add_u32 s77, s77, 10752
v_max_f32 v124, v124, v128
v_max_f32 v117, v117, v121
v_max_f32 v125, v125, v129
v_max_f32 v118, v118, v122
s_cmp_eq_u32 s77, s81
s_cselect_b32 s77, s80, s77
v_max_f32 v126, v126, v130
v_max_f32 v119, v119, v123
v_max_f32 v127, v127, v131
v_max3_f32 v177, v116, v117, v118
s_add_u32 m0, s85, 16384
v_max3_f32 v181, v124, v125, v126
v_max_f32 v177, v177, v119
v_max_f32 v181, v181, v127
v_mov_b32 v178, v177
buffer_load_dwordx4 v12, s[40:43], s77 offen offset:0 lds
v_mov_b32 v182, v181
v_permlane16_swap_b32 v177, v178
s_nop 0
v_permlane16_swap_b32 v181, v182
v_max_f32 v177, v177, v178
buffer_load_dwordx4 v13, s[40:43], s77 offen offset:1024 lds
v_max_f32 v181, v181, v182
v_mul_f32 v177, v177, v176
v_mul_f32 v181, v181, v180
v_fma_f32 v116, v116, v176, -v177
s_add_u32 s77, s77, 14336
v_fma_f32 v124, v124, v180, -v181
v_fma_f32 v117, v117, v176, -v177
v_fma_f32 v125, v125, v180, -v181
v_fma_f32 v118, v118, v176, -v177
s_add_u32 m0, s85, 65536
v_fma_f32 v126, v126, v180, -v181
v_fma_f32 v119, v119, v176, -v177
v_fma_f32 v127, v127, v180, -v181
v_exp_f32 v116, v116
buffer_load_dwordx4 v12, s[40:43], s77 offen offset:0 lds
v_exp_f32 v124, v124
v_exp_f32 v117, v117
v_exp_f32 v125, v125
v_exp_f32 v118, v118
buffer_load_dwordx4 v13, s[40:43], s77 offen offset:1024 lds
v_exp_f32 v126, v126
v_exp_f32 v119, v119
v_exp_f32 v127, v127
v_add_f32 v177, v116, v117
s_add_u32 s77, s77, 10752
v_add_f32 v181, v124, v125
v_add_f32 v178, v118, v119
v_add_f32 v182, v126, v127
v_add_f32 v177, v177, v178
s_cmp_eq_u32 s77, s81
s_cselect_b32 s77, s80, s77
v_add_f32 v181, v181, v182
v_mov_b32 v178, v177
v_mov_b32 v182, v181
s_nop 0
v_permlane16_swap_b32 v177, v178
buffer_load_dword v32, v27, s[32:35], 0 offen sc1
v_permlane16_swap_b32 v181, v182
v_add_f32 v177, v177, v178
v_add_f32 v181, v181, v182
v_rcp_f32 v177, v177
v_rcp_f32 v181, v181
v_mul_f32 v116, v116, v177
v_mul_f32 v124, v124, v181
v_mul_f32 v117, v117, v177
v_mul_f32 v125, v125, v181
v_mul_f32 v118, v118, v177
v_mul_f32 v126, v126, v181
v_mul_f32 v119, v119, v177
v_mul_f32 v127, v127, v181
PADQ3:
s_cbranch_execz BACK_Q
v_cvt_pk_bf16_f32 v116, v116, v117
v_cvt_pk_bf16_f32 v124, v124, v125
v_cvt_pk_bf16_f32 v117, v118, v119
v_cvt_pk_bf16_f32 v125, v126, v127
v_mov_b32 v120, v116
v_mov_b32 v128, v124
v_mov_b32 v121, v117
v_mov_b32 v129, v125
v_permlane32_swap_b32 v116, v120
v_permlane32_swap_b32 v124, v128
v_permlane32_swap_b32 v117, v121
v_permlane32_swap_b32 v125, v129
v_and_b32 v118, v116, v198
v_and_b32 v126, v124, v198
v_and_b32 v119, v117, v199
v_and_b32 v127, v125, v199
v_and_b32 v116, v116, v196
v_and_b32 v124, v124, v196
v_and_b32 v117, v117, v197
v_and_b32 v125, v125, v197
v_and_b32 v122, v120, v198
v_and_b32 v130, v128, v198
v_and_b32 v123, v121, v199
v_and_b32 v131, v129, v199
v_and_b32 v120, v120, v196
v_and_b32 v128, v128, v196
v_and_b32 v121, v121, v197
v_and_b32 v129, v129, v197
s_waitcnt lgkmcnt(0)
v_mfma_f32_16x16x32_bf16 v[76:79], a[76:79], v[116:119], 0
v_mfma_f32_16x16x32_bf16 v[156:159], a[86:89], v[116:119], 0
v_mfma_f32_16x16x32_bf16 v[80:83], a[78:81], v[120:123], 0
v_mfma_f32_16x16x32_bf16 v[160:163], a[88:91], v[120:123], 0
v_mfma_f32_16x16x32_bf16 v[84:87], a[80:83], v[124:127], 0
v_mfma_f32_16x16x32_bf16 v[164:167], a[90:93], v[124:127], 0
v_mfma_f32_16x16x32_bf16 v[88:91], a[82:85], v[128:131], 0
v_mfma_f32_16x16x32_bf16 v[168:171], a[92:95], v[128:131], 0
s_nop 0
s_nop 0
v_cvt_pk_bf16_f32 v92, v76, v77
v_cvt_pk_bf16_f32 v93, v78, v79
v_cvt_pk_bf16_f32 v94, v80, v81
v_cvt_pk_bf16_f32 v95, v82, v83
v_cvt_pk_bf16_f32 v100, v156, v157
v_cvt_pk_bf16_f32 v101, v158, v159
v_cvt_pk_bf16_f32 v102, v160, v161
v_cvt_pk_bf16_f32 v103, v162, v163
v_cvt_pk_bf16_f32 v96, v84, v85
v_cvt_pk_bf16_f32 v97, v86, v87
v_cvt_pk_bf16_f32 v98, v88, v89
v_cvt_pk_bf16_f32 v99, v90, v91
v_cvt_pk_bf16_f32 v104, v164, v165
v_cvt_pk_bf16_f32 v105, v166, v167
v_cvt_pk_bf16_f32 v106, v168, v169
v_cvt_pk_bf16_f32 v107, v170, v171
v_permlane16_swap_b32 v92, v94
v_permlane16_swap_b32 v93, v95
v_permlane16_swap_b32 v100, v102
v_permlane16_swap_b32 v101, v103
v_permlane16_swap_b32 v96, v98
v_permlane16_swap_b32 v97, v99
v_permlane16_swap_b32 v104, v106
v_permlane16_swap_b32 v105, v107
buffer_store_dwordx4 v[92:95], v225, s[32:35], s70 offen offset:0 sc1
buffer_store_dwordx4 v[100:103], v225, s[32:35], s70 offen offset:2048 sc1
buffer_store_dwordx4 v[96:99], v225, s[32:35], s70 offen offset:1024 sc1
buffer_store_dwordx4 v[104:107], v225, s[32:35], s70 offen offset:3072 sc1
buffer_store_dword v8, v224, s[32:35], 0 offen sc1
s_cmp_ge_u32 s2, 224
s_cbranch_scc1 Q_FIN
s_waitcnt vmcnt(5)
v_cmp_eq_u32 vcc, s86, v32
s_and_b32 s63, vcc_lo, 3
s_cmp_lg_u32 s63, 3
s_cbranch_scc1 PF_Q_S
PF_Q_X:
buffer_load_dwordx4 v[208:211], v10, s[32:35], s66 offen offset:0 sc1
buffer_load_dwordx4 v[212:215], v10, s[32:35], s66 offen offset:2048 sc1
buffer_load_dwordx4 v[216:219], v10, s[32:35], s6 offen offset:0 sc1
buffer_load_dwordx4 v[220:223], v10, s[32:35], s6 offen offset:2048 sc1
buffer_load_dwordx4 v[224:227], v10, s[32:35], s7 offen offset:0 sc1
buffer_load_dwordx4 v[228:231], v10, s[32:35], s7 offen offset:2048 sc1
buffer_load_dwordx4 v[232:235], v10, s[32:35], s8 offen offset:0 sc1
buffer_load_dwordx4 v[236:239], v10, s[32:35], s8 offen offset:2048 sc1
buffer_load_dwordx4 v[240:243], v10, s[32:35], s9 offen offset:0 sc1
buffer_load_dwordx4 v[244:247], v10, s[32:35], s9 offen offset:2048 sc1
s_waitcnt vmcnt(54) lgkmcnt(0)
s_waitcnt vmcnt(8)
s_barrier
s_lshl_b32 s63, s2, 7
s_add_u32 s63, s63, 9502720
s_cmp_eq_u32 s3, 0
s_cselect_b32 s63, s63, 0x80000000
v_lshl_add_u32 v8, v0, 2, s63
v_mov_b32 v9, s86
s_mov_b32 exec_hi, 0
buffer_store_dword v9, v8, s[32:35], 0 offen sc1
s_mov_b64 exec, -1
v_mfma_f32_32x32x16_bf16 v[56:71], a[164:167], v[208:211], 0
ds_read_b64_tr_b16 a[0:1], v18 offset:8192
ds_read_b64_tr_b16 a[2:3], v18 offset:8704
buffer_load_dwordx4 v[248:251], v10, s[32:35], s10 offen offset:0 sc1
v_and_b32 v6, 31, v0
v_lshrrev_b32 v7, 5, v0
v_mfma_f32_32x32x16_bf16 v[40:55], a[160:163], v[208:211], 0
ds_read_b64_tr_b16 a[4:5], v19 offset:8192
ds_read_b64_tr_b16 a[6:7], v19 offset:8704
ds_read_b64_tr_b16 a[8:9], v18 offset:16384
v_lshlrev_b32 v159, 4, v0
v_mfma_f32_32x32x16_bf16 v[56:71], a[172:175], v[212:215], v[56:71]
ds_read_b64_tr_b16 a[10:11], v18 offset:16896
buffer_load_dwordx4 v[252:255], v10, s[32:35], s10 offen offset:2048 sc1
ds_read_b64_tr_b16 a[12:13], v19 offset:16384
s_and_b32 s70, s74, 1
ds_read_b64_tr_b16 a[14:15], v19 offset:16896
v_mfma_f32_32x32x16_bf16 v[40:55], a[168:171], v[212:215], v[40:55]
s_waitcnt vmcnt(9)
v_mfma_f32_32x32x16_bf16 v[56:71], a[180:183], v[216:219], v[56:71]
ds_read_b64_tr_b16 a[16:17], v14 offset:24576
ds_read_b64_tr_b16 a[18:19], v14 offset:25088
buffer_load_dwordx4 v[208:211], v10, s[32:35], s11 offen offset:0 sc1
s_mul_i32 s70, s70, 589824
s_sub_u32 s70, s70, 294912
v_mfma_f32_32x32x16_bf16 v[40:55], a[176:179], v[216:219], v[40:55]
ds_read_b64_tr_b16 a[20:21], v15 offset:24576
ds_read_b64_tr_b16 a[22:23], v15 offset:25088
v_add_u32 v174, s70, v10
v_add_u32 v175, s70, v11
v_mfma_f32_32x32x16_bf16 v[56:71], a[188:191], v[220:223], v[56:71]
ds_read_b64_tr_b16 a[24:25], v16 offset:16384
ds_read_b64_tr_b16 a[26:27], v16 offset:16896
buffer_load_dwordx4 v[212:215], v10, s[32:35], s11 offen offset:2048 sc1
ds_read_b64_tr_b16 a[28:29], v17 offset:16384
s_mul_i32 s70, s74, 288
v_mfma_f32_32x32x16_bf16 v[40:55], a[184:187], v[220:223], v[40:55]
ds_read_b64_tr_b16 a[30:31], v17 offset:16896
s_waitcnt vmcnt(9)
s_waitcnt lgkmcnt(8)
v_mfma_f32_32x32x16_bf16 v[56:71], a[4:7], v[224:227], v[56:71]
ds_read_b64_tr_b16 a[32:33], v14 offset:32768
ds_read_b64_tr_b16 a[34:35], v14 offset:33280
buffer_load_dwordx4 v[216:219], v11, s[32:35], s66 offen offset:0 sc1
s_add_u32 s70, s70, s72
s_lshl_b32 s70, s70, 10
v_mfma_f32_32x32x16_bf16 v[40:55], a[0:3], v[224:227], v[40:55]
ds_read_b64_tr_b16 a[36:37], v15 offset:32768
ds_read_b64_tr_b16 a[38:39], v15 offset:33280
ds_read_b64_tr_b16 a[40:41], v14 offset:40960
v_add_u32 v3, s70, v159
v_mfma_f32_32x32x16_bf16 v[56:71], a[12:15], v[228:231], v[56:71]
ds_read_b64_tr_b16 a[42:43], v14 offset:41472
buffer_load_dwordx4 v[220:223], v11, s[32:35], s66 offen offset:2048 sc1
ds_read_b64_tr_b16 a[44:45], v15 offset:40960
s_lshl_b32 s70, s3, 14
ds_read_b64_tr_b16 a[46:47], v15 offset:41472
v_mfma_f32_32x32x16_bf16 v[40:55], a[8:11], v[228:231], v[40:55]
s_waitcnt vmcnt(9)
s_waitcnt lgkmcnt(8)
v_mfma_f32_32x32x16_bf16 v[56:71], a[20:23], v[232:235], v[56:71]
ds_read_b64_tr_b16 a[48:49], v16 offset:24576
ds_read_b64_tr_b16 a[50:51], v16 offset:25088
buffer_load_dwordx4 v[224:227], v11, s[32:35], s6 offen offset:0 sc1
v_add_u32 v176, s70, v3
s_xor_b32 s70, s70, 16384
v_mfma_f32_32x32x16_bf16 v[40:55], a[16:19], v[232:235], v[40:55]
ds_read_b64_tr_b16 a[52:53], v17 offset:24576
ds_read_b64_tr_b16 a[54:55], v17 offset:25088
v_add_u32 v177, s70, v3
s_lshl_b32 s70, s2, 2
v_mfma_f32_32x32x16_bf16 v[56:71], a[28:31], v[236:239], v[56:71]
ds_read_b64_tr_b16 a[56:57], v16 offset:32768
ds_read_b64_tr_b16 a[58:59], v16 offset:33280
buffer_load_dwordx4 v[228:231], v11, s[32:35], s6 offen offset:2048 sc1
ds_read_b64_tr_b16 a[60:61], v17 offset:32768
s_add_u32 s70, s70, s3
v_mfma_f32_32x32x16_bf16 v[40:55], a[24:27], v[236:239], v[40:55]
ds_read_b64_tr_b16 a[62:63], v17 offset:33280
s_waitcnt vmcnt(9)
s_waitcnt lgkmcnt(8)
v_mfma_f32_32x32x16_bf16 v[56:71], a[36:39], v[240:243], v[56:71]
ds_read_b64_tr_b16 a[64:65], v14 offset:49152
ds_read_b64_tr_b16 a[66:67], v14 offset:49664
buffer_load_dwordx4 v[232:235], v11, s[32:35], s7 offen offset:0 sc1
s_mul_i32 s71, s70, 3072
s_add_u32 s71, s71, 10059776
v_mfma_f32_32x32x16_bf16 v[40:55], a[32:35], v[240:243], v[40:55]
ds_read_b64_tr_b16 a[68:69], v15 offset:49152
ds_read_b64_tr_b16 a[70:71], v15 offset:49664
ds_read_b64_tr_b16 a[72:73], v14 offset:57344
v_add_u32 v171, s71, v159
v_mfma_f32_32x32x16_bf16 v[56:71], a[44:47], v[244:247], v[56:71]
ds_read_b64_tr_b16 a[74:75], v14 offset:57856
buffer_load_dwordx4 v[236:239], v11, s[32:35], s7 offen offset:2048 sc1
ds_read_b64_tr_b16 a[76:77], v15 offset:57344
s_xor_b32 s71, s70, 4
ds_read_b64_tr_b16 a[78:79], v15 offset:57856
v_mfma_f32_32x32x16_bf16 v[40:55], a[40:43], v[244:247], v[40:55]
s_waitcnt vmcnt(8)
s_waitcnt lgkmcnt(8)
v_mfma_f32_32x32x16_bf16 v[56:71], a[52:55], v[248:251], v[56:71]
buffer_load_dwordx4 v[240:243], v11, s[32:35], s8 offen offset:0 sc1
s_mul_i32 s71, s71, 3072
s_add_u32 s71, s71, 10059776
v_add_u32 v170, s71, v159
v_mfma_f32_32x32x16_bf16 v[40:55], a[48:51], v[248:251], v[40:55]
v_mov_b32 v139, s86
buffer_load_dwordx4 v[244:247], v11, s[32:35], s8 offen offset:2048 sc1
v_mfma_f32_32x32x16_bf16 v[56:71], a[60:63], v[252:255], v[56:71]
v_mov_b32 v143, s86
v_mfma_f32_32x32x16_bf16 v[40:55], a[56:59], v[252:255], v[40:55]
s_waitcnt vmcnt(8)
s_waitcnt lgkmcnt(0)
v_mfma_f32_32x32x16_bf16 v[56:71], a[68:71], v[208:211], v[56:71]
buffer_load_dwordx4 v[248:251], v11, s[32:35], s9 offen offset:0 sc1
v_mov_b32 v147, s86
s_mov_b32 s28, s16
v_mfma_f32_32x32x16_bf16 v[40:55], a[64:67], v[208:211], v[40:55]
s_mov_b32 s29, s17
buffer_load_dwordx4 v[252:255], v11, s[32:35], s9 offen offset:2048 sc1
v_mfma_f32_32x32x16_bf16 v[56:71], a[76:79], v[212:215], v[56:71]
s_mov_b32 s30, 1835008
v_mfma_f32_32x32x16_bf16 v[40:55], a[72:75], v[212:215], v[40:55]
s_waitcnt vmcnt(8)
s_barrier
v_mfma_f32_32x32x16_bf16 v[56:71], a[196:199], v[216:219], v[56:71]
ds_read_b64_tr_b16 a[80:81], v24 offset:8192
ds_read_b64_tr_b16 a[82:83], v24 offset:8704
buffer_load_dwordx4 v[208:211], v11, s[32:35], s10 offen offset:0 sc1
s_lshl_b32 s71, s72, 12
s_add_u32 s71, s71, 155648
v_mfma_f32_32x32x16_bf16 v[40:55], a[192:195], v[216:219], v[40:55]
ds_read_b64_tr_b16 a[84:85], v25 offset:8192
ds_read_b64_tr_b16 a[86:87], v25 offset:8704
v_lshlrev_b32 v3, 7, v6
v_lshl_add_u32 v3, v7, 3, v3
v_mfma_f32_32x32x16_bf16 v[56:71], a[204:207], v[220:223], v[56:71]
ds_read_b64_tr_b16 a[88:89], v24 offset:16384
ds_read_b64_tr_b16 a[90:91], v24 offset:16896
buffer_load_dwordx4 v[212:215], v11, s[32:35], s10 offen offset:2048 sc1
ds_read_b64_tr_b16 a[92:93], v25 offset:16384
s_lshl_b32 s68, s73, 2
v_mfma_f32_32x32x16_bf16 v[40:55], a[200:203], v[220:223], v[40:55]
ds_read_b64_tr_b16 a[94:95], v25 offset:16896
s_waitcnt vmcnt(8)
v_mfma_f32_32x32x16_bf16 v[56:71], a[212:215], v[224:227], v[56:71]
ds_read_b64_tr_b16 a[96:97], v20 offset:24576
ds_read_b64_tr_b16 a[98:99], v20 offset:25088
buffer_load_dwordx4 v[216:219], v11, s[32:35], s11 offen offset:0 sc1
v_and_b32 v4, 7, v0
v_xor_b32 v4, s68, v4
v_mfma_f32_32x32x16_bf16 v[40:55], a[208:211], v[224:227], v[40:55]
ds_read_b64_tr_b16 a[100:101], v21 offset:24576
ds_read_b64_tr_b16 a[102:103], v21 offset:25088
ds_read_b64_tr_b16 a[104:105], v22 offset:16384
v_lshl_add_u32 v3, v4, 4, v3
v_mfma_f32_32x32x16_bf16 v[56:71], a[220:223], v[228:231], v[56:71]
ds_read_b64_tr_b16 a[106:107], v22 offset:16896
buffer_load_dwordx4 v[220:223], v11, s[32:35], s11 offen offset:2048 sc1
ds_read_b64_tr_b16 a[108:109], v23 offset:16384
v_add_u32 v168, s71, v3
v_mfma_f32_32x32x16_bf16 v[40:55], a[216:219], v[228:231], v[40:55]
ds_read_b64_tr_b16 a[110:111], v23 offset:16896
s_waitcnt vmcnt(8)
s_waitcnt lgkmcnt(8)
v_mfma_f32_32x32x16_bf16 v[56:71], a[84:87], v[232:235], v[56:71]
ds_read_b64_tr_b16 a[112:113], v20 offset:32768
ds_read_b64_tr_b16 a[114:115], v20 offset:33280
buffer_load_dwordx4 v[224:227], v174, s[32:35], s66 offen offset:0 sc1
s_mul_i32 s71, s72, 57344
s_add_u32 s71, s71, s84
v_mfma_f32_32x32x16_bf16 v[40:55], a[80:83], v[232:235], v[40:55]
ds_read_b64_tr_b16 a[116:117], v21 offset:32768
ds_read_b64_tr_b16 a[118:119], v21 offset:33280
s_lshl_b32 s68, s73, 6
ds_read_b64_tr_b16 a[120:121], v20 offset:40960
v_mfma_f32_32x32x16_bf16 v[56:71], a[92:95], v[236:239], v[56:71]
ds_read_b64_tr_b16 a[122:123], v20 offset:41472
buffer_load_dwordx4 v[228:231], v174, s[32:35], s66 offen offset:2048 sc1
ds_read_b64_tr_b16 a[124:125], v21 offset:40960
s_add_u32 s71, s71, s68
ds_read_b64_tr_b16 a[126:127], v21 offset:41472
v_mfma_f32_32x32x16_bf16 v[40:55], a[88:91], v[236:239], v[40:55]
v_mul_u32_u24 v3, 1792, v6
s_waitcnt vmcnt(8)
s_waitcnt lgkmcnt(8)
v_mfma_f32_32x32x16_bf16 v[56:71], a[100:103], v[240:243], v[56:71]
ds_read_b64_tr_b16 a[128:129], v22 offset:24576
ds_read_b64_tr_b16 a[130:131], v22 offset:25088
buffer_load_dwordx4 v[232:235], v174, s[32:35], s6 offen offset:0 sc1
v_add_u32 v3, s71, v3
v_lshl_add_u32 v158, v7, 4, v3
v_mfma_f32_32x32x16_bf16 v[40:55], a[96:99], v[240:243], v[40:55]
ds_read_b64_tr_b16 a[132:133], v23 offset:24576
ds_read_b64_tr_b16 a[134:135], v23 offset:25088
ds_read_b64_tr_b16 a[136:137], v22 offset:32768
s_lshl_b32 s71, s74, 1
v_mfma_f32_32x32x16_bf16 v[56:71], a[108:111], v[244:247], v[56:71]
ds_read_b64_tr_b16 a[138:139], v22 offset:33280
buffer_load_dwordx4 v[236:239], v174, s[32:35], s6 offen offset:2048 sc1
ds_read_b64_tr_b16 a[140:141], v23 offset:32768
s_add_u32 s71, s71, s72
ds_read_b64_tr_b16 a[142:143], v23 offset:33280
v_mfma_f32_32x32x16_bf16 v[40:55], a[104:107], v[244:247], v[40:55]
s_waitcnt vmcnt(8)
s_waitcnt lgkmcnt(8)
v_mfma_f32_32x32x16_bf16 v[56:71], a[116:119], v[248:251], v[56:71]
ds_read_b64_tr_b16 a[144:145], v20 offset:49152
ds_read_b64_tr_b16 a[146:147], v20 offset:49664
buffer_load_dwordx4 v[240:243], v174, s[32:35], s7 offen offset:0 sc1
s_lshl_b32 s71, s71, 7
s_lshl_b32 s68, s3, 14
v_mfma_f32_32x32x16_bf16 v[40:55], a[112:115], v[248:251], v[40:55]
ds_read_b64_tr_b16 a[148:149], v21 offset:49152
ds_read_b64_tr_b16 a[150:151], v21 offset:49664
s_add_u32 s71, s71, s68
ds_read_b64_tr_b16 a[152:153], v20 offset:57344
v_mfma_f32_32x32x16_bf16 v[56:71], a[124:127], v[252:255], v[56:71]
ds_read_b64_tr_b16 a[154:155], v20 offset:57856
buffer_load_dwordx4 v[244:247], v174, s[32:35], s7 offen offset:2048 sc1
ds_read_b64_tr_b16 a[156:157], v21 offset:57344
s_add_u32 s71, s71, 9437184
ds_read_b64_tr_b16 a[158:159], v21 offset:57856
v_mfma_f32_32x32x16_bf16 v[40:55], a[120:123], v[252:255], v[40:55]
v_lshl_add_u32 v169, v6, 2, s71
s_waitcnt vmcnt(8)
s_waitcnt lgkmcnt(8)
v_mfma_f32_32x32x16_bf16 v[56:71], a[132:135], v[208:211], v[56:71]
buffer_load_dwordx4 v[248:251], v174, s[32:35], s8 offen offset:0 sc1
s_add_u32 s71, s85, 0
v_add_u32 v172, s71, v159
v_xor_b32 v173, 4096, v172
v_mfma_f32_32x32x16_bf16 v[40:55], a[128:131], v[208:211], v[40:55]
s_mov_b32 s70, 0x3f80
buffer_load_dwordx4 v[252:255], v174, s[32:35], s8 offen offset:2048 sc1
v_mfma_f32_32x32x16_bf16 v[56:71], a[140:143], v[212:215], v[56:71]
s_mov_b32 s71, 0x3f800000
v_mfma_f32_32x32x16_bf16 v[40:55], a[136:139], v[212:215], v[40:55]
s_waitcnt vmcnt(8)
s_waitcnt lgkmcnt(0)
v_mfma_f32_32x32x16_bf16 v[56:71], a[148:151], v[216:219], v[56:71]
buffer_load_dwordx4 v[208:211], v174, s[32:35], s9 offen offset:0 sc1
v_mfma_f32_32x32x16_bf16 v[56:71], a[156:159], v[220:223], v[56:71]
buffer_load_dwordx4 v[212:215], v174, s[32:35], s9 offen offset:2048 sc1
v_mfma_f32_32x32x16_bf16 v[40:55], a[144:147], v[216:219], v[40:55]
v_mfma_f32_32x32x16_bf16 v[40:55], a[152:155], v[220:223], v[40:55]
s_waitcnt vmcnt(8)
s_barrier
v_mfma_f32_32x32x16_bf16 v[88:103], a[164:167], v[224:227], 0
buffer_load_dwordx4 v[216:219], v174, s[32:35], s10 offen offset:0 sc1
v_mfma_f32_32x32x16_bf16 v[72:87], a[160:163], v[224:227], 0
s_nop 3
ds_write_b128 v172, v[56:59] offset:40960
buffer_load_dwordx4 v[220:223], v174, s[32:35], s10 offen offset:2048 sc1
v_mfma_f32_32x32x16_bf16 v[88:103], a[172:175], v[228:231], v[88:103]
v_mfma_f32_32x32x16_bf16 v[72:87], a[168:171], v[228:231], v[72:87]
ds_write_b128 v172, v[60:63] offset:41984
s_waitcnt vmcnt(8)
v_mfma_f32_32x32x16_bf16 v[88:103], a[180:183], v[232:235], v[88:103]
buffer_load_dwordx4 v[224:227], v174, s[32:35], s11 offen offset:0 sc1
v_mfma_f32_32x32x16_bf16 v[72:87], a[176:179], v[232:235], v[72:87]
ds_write_b128 v172, v[64:67] offset:49152
buffer_load_dwordx4 v[228:231], v174, s[32:35], s11 offen offset:2048 sc1
v_mfma_f32_32x32x16_bf16 v[88:103], a[188:191], v[236:239], v[88:103]
v_mfma_f32_32x32x16_bf16 v[72:87], a[184:187], v[236:239], v[72:87]
ds_write_b128 v172, v[68:71] offset:50176
s_waitcnt vmcnt(8)
s_waitcnt lgkmcnt(0)
s_barrier
v_mfma_f32_32x32x16_bf16 v[88:103], a[4:7], v[240:243], v[88:103]
ds_read_b128 v[56:59], v173 offset:40960
buffer_load_dwordx4 v[232:235], v175, s[32:35], s66 offen offset:0 sc1
ds_read_b128 v[60:63], v173 offset:41984
v_mfma_f32_32x32x16_bf16 v[72:87], a[0:3], v[240:243], v[72:87]
ds_read_b128 v[64:67], v173 offset:49152
buffer_load_dwordx4 v[236:239], v175, s[32:35], s66 offen offset:2048 sc1
v_mfma_f32_32x32x16_bf16 v[88:103], a[12:15], v[244:247], v[88:103]
ds_read_b128 v[68:71], v173 offset:50176
v_mfma_f32_32x32x16_bf16 v[72:87], a[8:11], v[244:247], v[72:87]
s_waitcnt vmcnt(8)
v_mfma_f32_32x32x16_bf16 v[88:103], a[20:23], v[248:251], v[88:103]
buffer_load_dwordx4 v[240:243], v175, s[32:35], s6 offen offset:0 sc1
s_waitcnt lgkmcnt(0)
v_add_f32 v40, v40, v56
v_add_f32 v41, v41, v57
v_cvt_pk_bf16_f32 v136, v40, v41
v_add_f32 v42, v42, v58
v_mfma_f32_32x32x16_bf16 v[72:87], a[16:19], v[248:251], v[72:87]
v_add_f32 v43, v43, v59
v_cvt_pk_bf16_f32 v137, v42, v43
v_add_f32 v44, v44, v60
v_add_f32 v45, v45, v61
v_cvt_pk_bf16_f32 v138, v44, v45
v_mfma_f32_32x32x16_bf16 v[88:103], a[28:31], v[252:255], v[88:103]
buffer_load_dwordx4 v[244:247], v175, s[32:35], s6 offen offset:2048 sc1
buffer_store_dwordx4 v[136:139], v170, s[32:35], 0 offen offset:0 sc1
v_add_f32 v46, v46, v62
v_add_f32 v47, v47, v63
v_cvt_pk_bf16_f32 v140, v46, v47
v_mfma_f32_32x32x16_bf16 v[72:87], a[24:27], v[252:255], v[72:87]
s_waitcnt vmcnt(9)
v_mfma_f32_32x32x16_bf16 v[88:103], a[36:39], v[208:211], v[88:103]
buffer_load_dwordx4 v[248:251], v175, s[32:35], s7 offen offset:0 sc1
v_add_f32 v48, v48, v64
v_add_f32 v49, v49, v65
v_cvt_pk_bf16_f32 v141, v48, v49
v_add_f32 v50, v50, v66
v_add_f32 v51, v51, v67
v_mfma_f32_32x32x16_bf16 v[72:87], a[32:35], v[208:211], v[72:87]
v_cvt_pk_bf16_f32 v142, v50, v51
buffer_store_dwordx4 v[140:143], v170, s[32:35], 0 offen offset:1024 sc1
v_add_f32 v52, v52, v68
v_add_f32 v53, v53, v69
v_mfma_f32_32x32x16_bf16 v[88:103], a[44:47], v[212:215], v[88:103]
buffer_load_dwordx4 v[252:255], v175, s[32:35], s7 offen offset:2048 sc1
v_cvt_pk_bf16_f32 v144, v52, v53
v_add_f32 v54, v54, v70
v_add_f32 v55, v55, v71
v_cvt_pk_bf16_f32 v145, v54, v55
v_mfma_f32_32x32x16_bf16 v[72:87], a[40:43], v[212:215], v[72:87]
buffer_store_dwordx4 v[144:147], v170, s[32:35], 0 offen offset:2048 sc1
s_waitcnt vmcnt(11)
v_mfma_f32_32x32x16_bf16 v[88:103], a[52:55], v[216:219], v[88:103]
ds_read_b64_tr_b16 a[160:161], v16 offset:40960
buffer_load_dword v32, v27, s[32:35], 0 offen sc1
ds_read_b64_tr_b16 a[162:163], v16 offset:41472
ds_read_b64_tr_b16 a[164:165], v17 offset:40960
buffer_load_dwordx4 v[208:211], v175, s[32:35], s8 offen offset:0 sc1
v_mfma_f32_32x32x16_bf16 v[72:87], a[48:51], v[216:219], v[72:87]
ds_read_b64_tr_b16 a[166:167], v17 offset:41472
ds_read_b64_tr_b16 a[168:169], v16 offset:49152
ds_read_b64_tr_b16 a[170:171], v16 offset:49664
buffer_load_dwordx4 v[212:215], v175, s[32:35], s8 offen offset:2048 sc1
v_mfma_f32_32x32x16_bf16 v[88:103], a[60:63], v[220:223], v[88:103]
ds_read_b64_tr_b16 a[172:173], v17 offset:49152
ds_read_b64_tr_b16 a[174:175], v17 offset:49664
v_mfma_f32_32x32x16_bf16 v[72:87], a[56:59], v[220:223], v[72:87]
s_waitcnt vmcnt(12)
v_mfma_f32_32x32x16_bf16 v[88:103], a[68:71], v[224:227], v[88:103]
ds_read_b64_tr_b16 a[176:177], v16 offset:57344
ds_read_b64_tr_b16 a[178:179], v16 offset:57856
buffer_load_dwordx4 v[216:219], v175, s[32:35], s9 offen offset:0 sc1
v_xor_b32 v3, 0, v168
v_mfma_f32_32x32x16_bf16 v[72:87], a[64:67], v[224:227], v[72:87]
ds_read_b64 v[148:149], v3
ds_read_b64_tr_b16 a[180:181], v17 offset:57344
ds_read_b64_tr_b16 a[182:183], v17 offset:57856
v_xor_b32 v3, 16, v168
v_mfma_f32_32x32x16_bf16 v[88:103], a[76:79], v[228:231], v[88:103]
ds_read_b64 v[150:151], v3
ds_read_b64_tr_b16 a[184:185], v18 offset:0
ds_read_b64_tr_b16 a[186:187], v18 offset:512
buffer_load_dwordx4 v[220:223], v175, s[32:35], s9 offen offset:2048 sc1
v_mfma_f32_32x32x16_bf16 v[72:87], a[72:75], v[228:231], v[72:87]
ds_read_b64_tr_b16 a[188:189], v19 offset:0
ds_read_b64_tr_b16 a[190:191], v19 offset:512
v_xor_b32 v3, 32, v168
ds_read_b64 v[152:153], v3
v_xor_b32 v3, 48, v168
ds_read_b64 v[154:155], v3
s_waitcnt vmcnt(12)
v_mfma_f32_32x32x16_bf16 v[88:103], a[196:199], v[232:235], v[88:103]
ds_read_b64_tr_b16 a[0:1], v14 offset:0
ds_read_b64_tr_b16 a[2:3], v14 offset:512
buffer_load_dwordx4 v[224:227], v175, s[32:35], s10 offen offset:0 sc1
s_waitcnt lgkmcnt(2)
v_lshlrev_b32 v56, 16, v148
v_mfma_f32_32x32x16_bf16 v[72:87], a[192:195], v[232:235], v[72:87]
ds_read_b64_tr_b16 a[4:5], v15 offset:0
ds_read_b64_tr_b16 a[6:7], v15 offset:512
v_and_b32 v57, 0xffff0000, v148
v_lshlrev_b32 v58, 16, v149
v_and_b32 v59, 0xffff0000, v149
v_mfma_f32_32x32x16_bf16 v[88:103], a[204:207], v[236:239], v[88:103]
ds_read_b64_tr_b16 a[8:9], v14 offset:8192
ds_read_b64_tr_b16 a[10:11], v14 offset:8704
buffer_load_dwordx4 v[228:231], v175, s[32:35], s10 offen offset:2048 sc1
ds_read_b64_tr_b16 a[12:13], v15 offset:8192
v_lshlrev_b32 v60, 16, v150
v_mfma_f32_32x32x16_bf16 v[72:87], a[200:203], v[236:239], v[72:87]
ds_read_b64_tr_b16 a[14:15], v15 offset:8704
v_and_b32 v61, 0xffff0000, v150
v_lshlrev_b32 v62, 16, v151
v_and_b32 v63, 0xffff0000, v151
s_waitcnt vmcnt(12)
v_mfma_f32_32x32x16_bf16 v[88:103], a[212:215], v[240:243], v[88:103]
ds_read_b64_tr_b16 a[16:17], v14 offset:16384
ds_read_b64_tr_b16 a[18:19], v14 offset:16896
buffer_load_dwordx4 v[232:235], v175, s[32:35], s11 offen offset:0 sc1
v_lshlrev_b32 v64, 16, v152
v_and_b32 v65, 0xffff0000, v152
v_mfma_f32_32x32x16_bf16 v[72:87], a[208:211], v[240:243], v[72:87]
ds_read_b64_tr_b16 a[20:21], v15 offset:16384
ds_read_b64_tr_b16 a[22:23], v15 offset:16896
v_lshlrev_b32 v66, 16, v153
v_and_b32 v67, 0xffff0000, v153
v_lshlrev_b32 v68, 16, v154
v_mfma_f32_32x32x16_bf16 v[88:103], a[220:223], v[244:247], v[88:103]
ds_read_b64_tr_b16 a[24:25], v16 offset:0
ds_read_b64_tr_b16 a[26:27], v16 offset:512
buffer_load_dwordx4 v[236:239], v175, s[32:35], s11 offen offset:2048 sc1
ds_read_b64_tr_b16 a[28:29], v17 offset:0
v_and_b32 v69, 0xffff0000, v154
v_mfma_f32_32x32x16_bf16 v[72:87], a[216:219], v[244:247], v[72:87]
ds_read_b64_tr_b16 a[30:31], v17 offset:512
v_lshlrev_b32 v70, 16, v155
v_and_b32 v71, 0xffff0000, v155
s_waitcnt vmcnt(10)
v_mfma_f32_32x32x16_bf16 v[88:103], a[84:87], v[248:251], v[88:103]
ds_read_b64_tr_b16 a[32:33], v22 offset:40960
ds_read_b64_tr_b16 a[34:35], v22 offset:41472
ds_read_b64_tr_b16 a[36:37], v23 offset:40960
v_mfma_f32_32x32x16_bf16 v[72:87], a[80:83], v[248:251], v[72:87]
ds_read_b64_tr_b16 a[38:39], v23 offset:41472
s_waitcnt vmcnt(8)
v_cmp_eq_u32 vcc, s86, v32
s_and_b32 s63, vcc_lo, 60
s_cmp_lg_u32 s63, 60
s_cbranch_scc1 PS_Q_S
PS_Q_X:
v_mfma_f32_32x32x16_bf16 v[88:103], a[92:95], v[252:255], v[88:103]
buffer_load_dword v156, v169, s[32:35], 0 offen sc1
ds_read_b64_tr_b16 a[40:41], v22 offset:49152
buffer_load_dwordx4 v[240:243], v176, s[32:35], s12 offen offset:0 sc1
ds_read_b64_tr_b16 a[42:43], v22 offset:49664
ds_read_b64_tr_b16 a[44:45], v23 offset:49152
v_mfma_f32_32x32x16_bf16 v[72:87], a[88:91], v[252:255], v[72:87]
buffer_load_dwordx4 v[244:247], v176, s[32:35], s12 offen offset:2048 sc1
ds_read_b64_tr_b16 a[46:47], v23 offset:49664
s_waitcnt vmcnt(9)
v_mfma_f32_32x32x16_bf16 v[88:103], a[100:103], v[208:211], v[88:103]
ds_read_b64_tr_b16 a[48:49], v22 offset:57344
ds_read_b64_tr_b16 a[50:51], v22 offset:57856
buffer_load_dwordx4 v[248:251], v176, s[32:35], s13 offen offset:0 sc1
ds_read_b64_tr_b16 a[52:53], v23 offset:57344
v_mfma_f32_32x32x16_bf16 v[72:87], a[96:99], v[208:211], v[72:87]
ds_read_b64_tr_b16 a[54:55], v23 offset:57856
ds_read_b64_tr_b16 a[56:57], v24 offset:0
ds_read_b64_tr_b16 a[58:59], v24 offset:512
buffer_load_dwordx4 v[252:255], v176, s[32:35], s13 offen offset:2048 sc1
v_mfma_f32_32x32x16_bf16 v[88:103], a[108:111], v[212:215], v[88:103]
ds_read_b64_tr_b16 a[60:61], v25 offset:0
ds_read_b64_tr_b16 a[62:63], v25 offset:512
v_mfma_f32_32x32x16_bf16 v[72:87], a[104:107], v[212:215], v[72:87]
s_waitcnt vmcnt(9)
v_mfma_f32_32x32x16_bf16 v[88:103], a[116:119], v[216:219], v[88:103]
ds_read_b64_tr_b16 a[64:65], v20 offset:0
ds_read_b64_tr_b16 a[66:67], v20 offset:512
buffer_load_dwordx4 v[208:211], v176, s[32:35], s14 offen offset:0 sc1
ds_read_b64_tr_b16 a[68:69], v21 offset:0
v_mfma_f32_32x32x16_bf16 v[72:87], a[112:115], v[216:219], v[72:87]
ds_read_b64_tr_b16 a[70:71], v21 offset:512
ds_read_b64_tr_b16 a[72:73], v20 offset:8192
ds_read_b64_tr_b16 a[74:75], v20 offset:8704
buffer_load_dwordx4 v[212:215], v176, s[32:35], s14 offen offset:2048 sc1
v_mfma_f32_32x32x16_bf16 v[88:103], a[124:127], v[220:223], v[88:103]
ds_read_b64_tr_b16 a[76:77], v21 offset:8192
ds_read_b64_tr_b16 a[78:79], v21 offset:8704
v_mfma_f32_32x32x16_bf16 v[72:87], a[120:123], v[220:223], v[72:87]
s_waitcnt vmcnt(9)
v_mfma_f32_32x32x16_bf16 v[88:103], a[132:135], v[224:227], v[88:103]
ds_read_b64_tr_b16 a[192:193], v20 offset:16384
ds_read_b64_tr_b16 a[194:195], v20 offset:16896
buffer_load_dwordx4 v[216:219], v176, s[32:35], s15 offen offset:0 sc1
ds_read_b64_tr_b16 a[196:197], v21 offset:16384
v_mfma_f32_32x32x16_bf16 v[72:87], a[128:131], v[224:227], v[72:87]
ds_read_b64_tr_b16 a[198:199], v21 offset:16896
ds_read_b64_tr_b16 a[200:201], v22 offset:0
ds_read_b64_tr_b16 a[202:203], v22 offset:512
buffer_load_dwordx4 v[220:223], v176, s[32:35], s15 offen offset:2048 sc1
v_mfma_f32_32x32x16_bf16 v[88:103], a[140:143], v[228:231], v[88:103]
ds_read_b64_tr_b16 a[204:205], v23 offset:0
ds_read_b64_tr_b16 a[206:207], v23 offset:512
v_mfma_f32_32x32x16_bf16 v[72:87], a[136:139], v[228:231], v[72:87]
s_waitcnt vmcnt(9)
v_mfma_f32_32x32x16_bf16 v[88:103], a[148:151], v[232:235], v[88:103]
buffer_load_dwordx4 v[224:227], v177, s[32:35], s12 offen offset:0 sc1
buffer_load_dwordx4 v[228:231], v177, s[32:35], s12 offen offset:2048 sc1
buffer_load_dwordx4 v[136:139], v171, s[32:35], 0 offen offset:0 sc1
v_mfma_f32_32x32x16_bf16 v[88:103], a[156:159], v[236:239], v[88:103]
buffer_load_dwordx4 v[140:143], v171, s[32:35], 0 offen offset:1024 sc1
v_mfma_f32_32x32x16_bf16 v[72:87], a[144:147], v[232:235], v[72:87]
buffer_load_dwordx4 v[144:147], v171, s[32:35], 0 offen offset:2048 sc1
v_mfma_f32_32x32x16_bf16 v[72:87], a[152:155], v[236:239], v[72:87]
s_waitcnt vmcnt(11)
s_waitcnt lgkmcnt(0)
v_mfma_f32_32x32x16_bf16 v[120:135], a[164:167], v[240:243], 0
buffer_load_dwordx4 v[232:235], v177, s[32:35], s13 offen offset:0 sc1
v_mfma_f32_32x32x16_bf16 v[104:119], a[160:163], v[240:243], 0
s_nop 2
ds_write_b128 v172, v[88:91] offset:24576
buffer_load_dwordx4 v[236:239], v177, s[32:35], s13 offen offset:2048 sc1
v_mfma_f32_32x32x16_bf16 v[120:135], a[172:175], v[244:247], v[120:135]
v_mfma_f32_32x32x16_bf16 v[104:119], a[168:171], v[244:247], v[104:119]
ds_write_b128 v172, v[92:95] offset:25600
s_waitcnt vmcnt(11)
v_mfma_f32_32x32x16_bf16 v[120:135], a[180:183], v[248:251], v[120:135]
buffer_load_dwordx4 v[240:243], v177, s[32:35], s14 offen offset:0 sc1
v_mfma_f32_32x32x16_bf16 v[104:119], a[176:179], v[248:251], v[104:119]
ds_write_b128 v172, v[96:99] offset:32768
PADQ4:
s_cbranch_execz BACK_Q
buffer_load_dwordx4 v[244:247], v177, s[32:35], s14 offen offset:2048 sc1
v_mfma_f32_32x32x16_bf16 v[120:135], a[188:191], v[252:255], v[120:135]
v_mfma_f32_32x32x16_bf16 v[104:119], a[184:187], v[252:255], v[104:119]
ds_write_b128 v172, v[100:103] offset:33792
s_waitcnt vmcnt(11)
s_waitcnt lgkmcnt(0)
s_barrier
v_mfma_f32_32x32x16_bf16 v[120:135], a[4:7], v[208:211], v[120:135]
ds_read_b128 v[88:91], v173 offset:24576
buffer_load_dwordx4 v[248:251], v177, s[32:35], s15 offen offset:0 sc1
ds_read_b128 v[92:95], v173 offset:25600
ds_read_b128 v[96:99], v173 offset:32768
v_mfma_f32_32x32x16_bf16 v[104:119], a[0:3], v[208:211], v[104:119]
ds_read_b128 v[100:103], v173 offset:33792
buffer_load_dwordx4 v[252:255], v177, s[32:35], s15 offen offset:2048 sc1
v_mfma_f32_32x32x16_bf16 v[120:135], a[12:15], v[212:215], v[120:135]
v_mul_f32 v157, 0xbfb8aa3b, v156
v_mfma_f32_32x32x16_bf16 v[104:119], a[8:11], v[212:215], v[104:119]
s_waitcnt vmcnt(11)
v_mfma_f32_32x32x16_bf16 v[120:135], a[20:23], v[216:219], v[120:135]
s_waitcnt lgkmcnt(0)
v_add_f32 v72, v72, v88
v_add_f32 v73, v73, v89
v_add_f32 v74, v74, v90
v_add_f32 v75, v75, v91
v_add_f32 v76, v76, v92
v_add_f32 v77, v77, v93
v_mfma_f32_32x32x16_bf16 v[104:119], a[16:19], v[216:219], v[104:119]
v_add_f32 v78, v78, v94
v_add_f32 v79, v79, v95
v_add_f32 v80, v80, v96
v_add_f32 v81, v81, v97
v_add_f32 v82, v82, v98
v_add_f32 v83, v83, v99
v_mfma_f32_32x32x16_bf16 v[120:135], a[28:31], v[220:223], v[120:135]
v_add_f32 v84, v84, v100
v_add_f32 v85, v85, v101
v_add_f32 v86, v86, v102
v_add_f32 v87, v87, v103
v_mfma_f32_32x32x16_bf16 v[104:119], a[24:27], v[220:223], v[104:119]
s_waitcnt vmcnt(9)
v_mfma_f32_32x32x16_bf16 v[120:135], a[36:39], v[224:227], v[120:135]
s_waitcnt vmcnt(6)
v_xor_b32 v139, s86, v139
v_xor_b32 v143, s86, v143
v_xor_b32 v147, s86, v147
v_mfma_f32_32x32x16_bf16 v[104:119], a[32:35], v[224:227], v[104:119]
v_or3_b32 v139, v139, v143, v147
v_cmp_ne_u32 vcc, 0, v139
v_mfma_f32_32x32x16_bf16 v[120:135], a[44:47], v[228:231], v[120:135]
s_cmp_lg_u64 vcc, 0
s_cbranch_scc1 XG_SQ
XG_XQ:
v_mfma_f32_32x32x16_bf16 v[104:119], a[40:43], v[228:231], v[104:119]
s_waitcnt vmcnt(4)
v_mfma_f32_32x32x16_bf16 v[120:135], a[52:55], v[232:235], v[120:135]
v_lshlrev_b32 v40, 16, v136
v_and_b32 v41, 0xffff0000, v136
v_lshlrev_b32 v42, 16, v137
v_and_b32 v43, 0xffff0000, v137
v_add_f32 v72, v72, v40
v_add_f32 v73, v73, v41
v_mfma_f32_32x32x16_bf16 v[104:119], a[48:51], v[232:235], v[104:119]
v_add_f32 v74, v74, v42
v_add_f32 v75, v75, v43
v_mul_f32 v40, v72, v157
v_mul_f32 v41, v73, v157
v_mul_f32 v42, v74, v157
v_mul_f32 v43, v75, v157
v_mfma_f32_32x32x16_bf16 v[120:135], a[60:63], v[236:239], v[120:135]
v_exp_f32 v40, v40
v_exp_f32 v41, v41
v_exp_f32 v42, v42
v_mfma_f32_32x32x16_bf16 v[104:119], a[56:59], v[236:239], v[104:119]
v_exp_f32 v43, v43
v_mul_f32 v72, v72, v156
v_mul_f32 v73, v73, v156
v_mul_f32 v74, v74, v156
v_mul_f32 v75, v75, v156
v_add_f32 v40, 1.0, v40
s_waitcnt vmcnt(2)
v_mfma_f32_32x32x16_bf16 v[120:135], a[68:71], v[240:243], v[120:135]
v_add_f32 v41, 1.0, v41
v_add_f32 v42, 1.0, v42
v_add_f32 v43, 1.0, v43
v_rcp_f32 v40, v40
v_mfma_f32_32x32x16_bf16 v[104:119], a[64:67], v[240:243], v[104:119]
v_rcp_f32 v41, v41
v_rcp_f32 v42, v42
v_rcp_f32 v43, v43
v_mfma_f32_32x32x16_bf16 v[120:135], a[76:79], v[244:247], v[120:135]
v_mul_f32 v72, v72, v40
v_mul_f32 v73, v73, v41
v_mul_f32 v74, v74, v42
v_mul_f32 v75, v75, v43
v_lshlrev_b32 v44, 16, v138
v_and_b32 v45, 0xffff0000, v138
v_mfma_f32_32x32x16_bf16 v[104:119], a[72:75], v[244:247], v[104:119]
v_lshlrev_b32 v46, 16, v140
v_and_b32 v47, 0xffff0000, v140
v_add_f32 v76, v76, v44
v_add_f32 v77, v77, v45
v_add_f32 v78, v78, v46
v_add_f32 v79, v79, v47
v_mul_f32 v44, v76, v157
v_mul_f32 v45, v77, v157
s_waitcnt vmcnt(0)
v_mfma_f32_32x32x16_bf16 v[120:135], a[196:199], v[248:251], v[120:135]
v_mul_f32 v46, v78, v157
v_mul_f32 v47, v79, v157
v_exp_f32 v44, v44
v_exp_f32 v45, v45
v_mfma_f32_32x32x16_bf16 v[120:135], a[204:207], v[252:255], v[120:135]
v_exp_f32 v46, v46
v_exp_f32 v47, v47
v_mul_f32 v76, v76, v156
v_mul_f32 v77, v77, v156
v_mfma_f32_32x32x16_bf16 v[104:119], a[192:195], v[248:251], v[104:119]
v_mul_f32 v78, v78, v156
v_mul_f32 v79, v79, v156
v_add_f32 v44, 1.0, v44
v_add_f32 v45, 1.0, v45
v_add_f32 v46, 1.0, v46
v_add_f32 v47, 1.0, v47
v_mfma_f32_32x32x16_bf16 v[104:119], a[200:203], v[252:255], v[104:119]
v_rcp_f32 v44, v44
v_rcp_f32 v45, v45
v_rcp_f32 v46, v46
v_rcp_f32 v47, v47
v_mul_f32 v76, v76, v44
v_mul_f32 v77, v77, v45
v_mul_f32 v78, v78, v46
v_mul_f32 v79, v79, v47
v_dot2c_f32_bf16 v80, s70, v141
ds_write_b128 v172, v[120:123] offset:40960
v_dot2c_f32_bf16 v81, s71, v141
v_dot2c_f32_bf16 v82, s70, v142
v_dot2c_f32_bf16 v83, s71, v142
ds_write_b128 v172, v[124:127] offset:41984
v_dot2c_f32_bf16 v84, s70, v144
v_dot2c_f32_bf16 v85, s71, v144
v_dot2c_f32_bf16 v86, s70, v145
v_dot2c_f32_bf16 v87, s71, v145
ds_write_b128 v172, v[128:131] offset:49152
v_pk_mul_f32 v[48:49], v[80:81], v[156:157] op_sel:[0,1] op_sel_hi:[1,1]
v_pk_mul_f32 v[50:51], v[82:83], v[156:157] op_sel:[0,1] op_sel_hi:[1,1]
v_exp_f32 v48, v48
ds_write_b128 v172, v[132:135] offset:50176
v_exp_f32 v49, v49
v_exp_f32 v50, v50
v_exp_f32 v51, v51
s_waitcnt lgkmcnt(0)
s_barrier
ds_read_b128 v[120:123], v173 offset:40960
ds_read_b128 v[124:127], v173 offset:41984
ds_read_b128 v[128:131], v173 offset:49152
ds_read_b128 v[132:135], v173 offset:50176
v_pk_mul_f32 v[80:81], v[80:81], v[156:157] op_sel_hi:[1,0]
v_pk_mul_f32 v[82:83], v[82:83], v[156:157] op_sel_hi:[1,0]
v_pk_add_f32 v[48:49], v[48:49], 1.0 op_sel_hi:[1,0]
v_pk_add_f32 v[50:51], v[50:51], 1.0 op_sel_hi:[1,0]
v_rcp_f32 v48, v48
v_rcp_f32 v49, v49
v_rcp_f32 v50, v50
v_rcp_f32 v51, v51
v_pk_mul_f32 v[80:81], v[80:81], v[48:49]
v_pk_mul_f32 v[82:83], v[82:83], v[50:51]
v_pk_mul_f32 v[52:53], v[84:85], v[156:157] op_sel:[0,1] op_sel_hi:[1,1]
v_pk_mul_f32 v[54:55], v[86:87], v[156:157] op_sel:[0,1] op_sel_hi:[1,1]
v_exp_f32 v52, v52
v_exp_f32 v53, v53
v_exp_f32 v54, v54
v_exp_f32 v55, v55
v_pk_mul_f32 v[84:85], v[84:85], v[156:157] op_sel_hi:[1,0]
v_pk_mul_f32 v[86:87], v[86:87], v[156:157] op_sel_hi:[1,0]
v_pk_add_f32 v[52:53], v[52:53], 1.0 op_sel_hi:[1,0]
v_pk_add_f32 v[54:55], v[54:55], 1.0 op_sel_hi:[1,0]
v_rcp_f32 v52, v52
v_rcp_f32 v53, v53
v_rcp_f32 v54, v54
v_rcp_f32 v55, v55
v_pk_mul_f32 v[84:85], v[84:85], v[52:53]
v_pk_mul_f32 v[86:87], v[86:87], v[54:55]
s_waitcnt lgkmcnt(3)
s_nop 0
v_pk_add_f32 v[104:105], v[104:105], v[120:121]
v_pk_add_f32 v[106:107], v[106:107], v[122:123]
v_pk_fma_f32 v[104:105], v[104:105], v[72:73], v[56:57]
v_pk_fma_f32 v[106:107], v[106:107], v[74:75], v[58:59]
v_cvt_pk_bf16_f32 v160, v104, v105
v_cvt_pk_bf16_f32 v161, v106, v107
s_waitcnt lgkmcnt(2)
s_nop 0
v_pk_add_f32 v[108:109], v[108:109], v[124:125]
v_pk_add_f32 v[110:111], v[110:111], v[126:127]
v_pk_fma_f32 v[108:109], v[108:109], v[76:77], v[60:61]
v_pk_fma_f32 v[110:111], v[110:111], v[78:79], v[62:63]
v_cvt_pk_bf16_f32 v162, v108, v109
v_cvt_pk_bf16_f32 v163, v110, v111
s_nop 0
v_permlane32_swap_b32 v160, v162
v_permlane32_swap_b32 v161, v163
buffer_store_dwordx4 v[160:163], v158, s[28:31], 0 offen offset:0
s_waitcnt lgkmcnt(1)
v_pk_add_f32 v[112:113], v[112:113], v[128:129]
v_pk_add_f32 v[114:115], v[114:115], v[130:131]
v_pk_fma_f32 v[112:113], v[112:113], v[80:81], v[64:65]
v_pk_fma_f32 v[114:115], v[114:115], v[82:83], v[66:67]
v_cvt_pk_bf16_f32 v164, v112, v113
v_cvt_pk_bf16_f32 v165, v114, v115
s_waitcnt lgkmcnt(0)
s_nop 0
v_pk_add_f32 v[116:117], v[116:117], v[132:133]
v_pk_add_f32 v[118:119], v[118:119], v[134:135]
v_pk_fma_f32 v[116:117], v[116:117], v[84:85], v[68:69]
v_pk_fma_f32 v[118:119], v[118:119], v[86:87], v[70:71]
v_cvt_pk_bf16_f32 v166, v116, v117
v_cvt_pk_bf16_f32 v167, v118, v119
s_nop 0
v_permlane32_swap_b32 v164, v166
v_permlane32_swap_b32 v165, v167
buffer_store_dwordx4 v[164:167], v158, s[28:31], 0 offen offset:32
s_endpgm
END_Q:
TAGSL_F:
s_mov_b32 s65, 0
TAGLP_F:
buffer_load_dword v29, v28, s[44:47], 0 offen sc1
s_waitcnt vmcnt(0)
v_readfirstlane_b32 s86, v29
s_add_u32 s65, s65, 1
s_cmp_ge_u32 s65, 1048576
s_cbranch_scc1 TAGOK_F
s_cmp_eq_u32 s86, 0
s_cbranch_scc1 TAGLP_F
s_branch TAGOK_F
GA_S:
s_mov_b32 s65, 0
GA_L:
buffer_load_dwordx4 v[168:171], v214, s[32:35], 0 offen offset:0 sc1
buffer_load_dwordx4 v[172:175], v214, s[32:35], 0 offen offset:512 sc1
buffer_load_dwordx4 v[176:179], v214, s[32:35], 0 offen offset:1024 sc1
buffer_load_dwordx4 v[180:183], v214, s[32:35], 0 offen offset:1536 sc1
buffer_load_dwordx4 v[184:187], v214, s[32:35], 0 offen offset:2048 sc1
buffer_load_dwordx4 v[188:191], v214, s[32:35], 0 offen offset:2560 sc1
buffer_load_dwordx4 v[192:195], v214, s[32:35], 0 offen offset:3072 sc1
s_waitcnt vmcnt(0)
v_xor_b32 v196, s86, v169
v_bitop3_b32 v196, v171, s86, v196 bitop3:0xbe
v_bitop3_b32 v196, v173, s86, v196 bitop3:0xbe
v_bitop3_b32 v196, v175, s86, v196 bitop3:0xbe
v_bitop3_b32 v196, v177, s86, v196 bitop3:0xbe
v_bitop3_b32 v196, v179, s86, v196 bitop3:0xbe
v_bitop3_b32 v196, v181, s86, v196 bitop3:0xbe
v_bitop3_b32 v196, v183, s86, v196 bitop3:0xbe
v_bitop3_b32 v196, v185, s86, v196 bitop3:0xbe
v_bitop3_b32 v196, v187, s86, v196 bitop3:0xbe
v_bitop3_b32 v196, v189, s86, v196 bitop3:0xbe
v_bitop3_b32 v196, v191, s86, v196 bitop3:0xbe
v_bitop3_b32 v196, v193, s86, v196 bitop3:0xbe
v_bitop3_b32 v196, v195, s86, v196 bitop3:0xbe
v_cmp_ne_u32 vcc, 0, v196
s_add_u32 s65, s65, 1
s_cmp_ge_u32 s65, 1048576
s_cbranch_scc1 GA_X
s_cmp_lg_u64 vcc, 0
s_cbranch_scc1 GA_L
s_branch GA_X
PF_F_S:
s_mov_b32 s65, 0
PF_F:
buffer_load_dword v32, v27, s[32:35], 0 offen sc1
s_waitcnt vmcnt(0)
v_cmp_eq_u32 vcc, s86, v32
s_add_u32 s65, s65, 1
s_cmp_ge_u32 s65, 1048576
s_cbranch_scc1 PF_F_X
s_and_b32 s63, vcc_lo, 3
s_cmp_lg_u32 s63, 3
s_cbranch_scc1 PF_F
s_branch PF_F_X
XG_SF:
s_mov_b32 s65, 0
s_mov_b64 exec, 1
XG_PF:
buffer_load_dword v147, v171, s[32:35], 0 offen offset:3068 sc1
s_waitcnt vmcnt(0)
v_readfirstlane_b32 s63, v147
s_add_u32 s65, s65, 1
s_cmp_ge_u32 s65, 4194304
s_cbranch_scc1 XG_QF
s_cmp_lg_u32 s63, s86
s_cbranch_scc1 XG_PF
XG_QF:
s_mov_b64 exec, -1
s_mov_b32 s65, 0
XG_LF:
buffer_load_dwordx4 v[136:139], v171, s[32:35], 0 offen offset:0 sc1
buffer_load_dwordx4 v[140:143], v171, s[32:35], 0 offen offset:1024 sc1
buffer_load_dwordx4 v[144:147], v171, s[32:35], 0 offen offset:2048 sc1
s_waitcnt vmcnt(0)
v_xor_b32 v139, s86, v139
v_xor_b32 v143, s86, v143
v_xor_b32 v147, s86, v147
v_or3_b32 v139, v139, v143, v147
v_cmp_ne_u32 vcc, 0, v139
s_add_u32 s65, s65, 1
s_cmp_ge_u32 s65, 1048576
s_cbranch_scc1 XG_XF
s_cmp_lg_u64 vcc, 0
s_cbranch_scc1 XG_LF
s_branch XG_XF
PS_F_S:
s_mov_b32 s65, 0
PS_F:
buffer_load_dword v32, v27, s[32:35], 0 offen sc1
s_waitcnt vmcnt(0)
v_cmp_eq_u32 vcc, s86, v32
s_add_u32 s65, s65, 1
s_cmp_ge_u32 s65, 1048576
s_cbranch_scc1 PS_F_X
s_and_b32 s63, vcc_lo, 60
s_cmp_lg_u32 s63, 60
s_cbranch_scc1 PS_F
s_branch PS_F_X
TAGSL_Q:
s_mov_b32 s65, 0
TAGLP_Q:
buffer_load_dword v29, v28, s[44:47], 0 offen sc1
s_waitcnt vmcnt(0)
v_readfirstlane_b32 s86, v29
s_add_u32 s65, s65, 1
s_cmp_ge_u32 s65, 1048576
s_cbranch_scc1 TAGOK_Q
s_cmp_eq_u32 s86, 0
s_cbranch_scc1 TAGLP_Q
s_branch TAGOK_Q
GQ_S:
s_mov_b32 s65, 0
GQ_L:
buffer_load_dwordx4 v[172:175], v221, s[32:35], 0 offen offset:0 sc1
buffer_load_dwordx4 v[176:179], v221, s[32:35], 0 offen offset:512 sc1
buffer_load_dwordx4 v[180:183], v221, s[32:35], 0 offen offset:1024 sc1
buffer_load_dwordx4 v[204:207], v221, s[32:35], 0 offen offset:1536 sc1
buffer_load_dwordx4 v[208:211], v221, s[32:35], 0 offen offset:2048 sc1
buffer_load_dwordx4 v[212:215], v221, s[32:35], 0 offen offset:2560 sc1
buffer_load_dwordx4 v[216:219], v221, s[32:35], 0 offen offset:3072 sc1
s_waitcnt vmcnt(0)
v_xor_b32 v8, s86, v173
v_bitop3_b32 v8, v175, s86, v8 bitop3:0xbe
v_bitop3_b32 v8, v177, s86, v8 bitop3:0xbe
v_bitop3_b32 v8, v179, s86, v8 bitop3:0xbe
v_bitop3_b32 v8, v181, s86, v8 bitop3:0xbe
v_bitop3_b32 v8, v183, s86, v8 bitop3:0xbe
v_bitop3_b32 v8, v205, s86, v8 bitop3:0xbe
v_bitop3_b32 v8, v207, s86, v8 bitop3:0xbe
v_bitop3_b32 v8, v209, s86, v8 bitop3:0xbe
v_bitop3_b32 v8, v211, s86, v8 bitop3:0xbe
v_bitop3_b32 v8, v213, s86, v8 bitop3:0xbe
v_bitop3_b32 v8, v215, s86, v8 bitop3:0xbe
v_bitop3_b32 v8, v217, s86, v8 bitop3:0xbe
v_bitop3_b32 v8, v219, s86, v8 bitop3:0xbe
v_cmp_ne_u32 vcc, 0, v8
s_add_u32 s65, s65, 1
s_cmp_ge_u32 s65, 1048576
s_cbranch_scc1 GQ_X
s_cmp_lg_u64 vcc, 0
s_cbranch_scc1 GQ_L
s_branch GQ_X
Q_FIN:
s_waitcnt vmcnt(0)
s_barrier
s_lshl_b32 s63, s2, 7
s_add_u32 s63, s63, 9502720
s_cmp_eq_u32 s3, 0
s_cselect_b32 s63, s63, 0x80000000
v_lshl_add_u32 v8, v0, 2, s63
v_mov_b32 v9, s86
s_mov_b32 exec_hi, 0
buffer_store_dword v9, v8, s[32:35], 0 offen sc1
s_mov_b64 exec, -1
s_endpgm
PF_Q_S:
s_mov_b32 s65, 0
PF_Q:
buffer_load_dword v32, v27, s[32:35], 0 offen sc1
s_waitcnt vmcnt(0)
v_cmp_eq_u32 vcc, s86, v32
s_add_u32 s65, s65, 1
s_cmp_ge_u32 s65, 1048576
s_cbranch_scc1 PF_Q_X
s_and_b32 s63, vcc_lo, 3
s_cmp_lg_u32 s63, 3
s_cbranch_scc1 PF_Q
s_branch PF_Q_X
XG_SQ:
s_mov_b32 s65, 0
s_mov_b64 exec, 1
XG_PQ:
buffer_load_dword v147, v171, s[32:35], 0 offen offset:3068 sc1
s_waitcnt vmcnt(0)
v_readfirstlane_b32 s63, v147
s_add_u32 s65, s65, 1
s_cmp_ge_u32 s65, 4194304
s_cbranch_scc1 XG_QQ
s_cmp_lg_u32 s63, s86
s_cbranch_scc1 XG_PQ
XG_QQ:
s_mov_b64 exec, -1
s_mov_b32 s65, 0
XG_LQ:
buffer_load_dwordx4 v[136:139], v171, s[32:35], 0 offen offset:0 sc1
buffer_load_dwordx4 v[140:143], v171, s[32:35], 0 offen offset:1024 sc1
buffer_load_dwordx4 v[144:147], v171, s[32:35], 0 offen offset:2048 sc1
s_waitcnt vmcnt(0)
v_xor_b32 v139, s86, v139
v_xor_b32 v143, s86, v143
v_xor_b32 v147, s86, v147
v_or3_b32 v139, v139, v143, v147
v_cmp_ne_u32 vcc, 0, v139
s_add_u32 s65, s65, 1
s_cmp_ge_u32 s65, 1048576
s_cbranch_scc1 XG_XQ
s_cmp_lg_u64 vcc, 0
s_cbranch_scc1 XG_LQ
s_branch XG_XQ
PS_Q_S:
s_mov_b32 s65, 0
PS_Q:
buffer_load_dword v32, v27, s[32:35], 0 offen sc1
s_waitcnt vmcnt(0)
v_cmp_eq_u32 vcc, s86, v32
s_add_u32 s65, s65, 1
s_cmp_ge_u32 s65, 1048576
s_cbranch_scc1 PS_Q_X
s_and_b32 s63, vcc_lo, 60
s_cmp_lg_u32 s63, 60
s_cbranch_scc1 PS_Q
s_branch PS_Q_X
K_END:
s_endpgm
.fill 8192, 4, 0xbf800000
.section .rodata,"a"
.p2align 6
.amdhsa_kernel recurrent_scan__sliding_local_dilated__dense_activation_relu__prompt_kernel
  .amdhsa_next_free_vgpr 512
  .amdhsa_next_free_sgpr 102
  .amdhsa_accum_offset 256
  .amdhsa_group_segment_fixed_size 0
  .amdhsa_kernarg_size 72
  .amdhsa_user_sgpr_count 2
  .amdhsa_user_sgpr_kernarg_segment_ptr 1
  .amdhsa_system_sgpr_workgroup_id_x 1
  .amdhsa_float_denorm_mode_32 3
.end_amdhsa_kernel
.text
```
